```python
import torch

def _softmax(x, axis=-1):
    return torch.softmax(x, dim=axis)
def _gelu(x):
    return torch.nn.functional.gelu(x, approximate="tanh")
def _silu(x):
    return torch.nn.functional.silu(x)
def _sigmoid(x):
    return torch.sigmoid(x)
def _layernorm(x, axis=-1, eps=1e-5):
    m = x.mean(dim=axis, keepdim=True)
    v = x.var(dim=axis, keepdim=True, unbiased=False)
    return (x - m) / torch.sqrt(v + eps)
def _scatter_add(tgt, idx, src, axis=0):
    return tgt.clone().index_add_(axis, idx, src)
def _segment_sum(src, seg, n):
    out = torch.zeros((n,) + src.shape[1:], dtype=src.dtype)
    return out.index_add_(0, seg, src)
def _pad(x, pw):
    flat = tuple(v for pair in reversed(pw) for v in pair)
    return torch.nn.functional.pad(x, flat)

kernel_name = 'interleave_layers__compressed_kv_cla__dense_activation_gelu__decode'

def setup_inputs():

    _w = (lambda a: (lambda t: t.to(torch.bfloat16) if t.is_floating_point() else t)(torch.as_tensor(a)))
    def _A_setup():
        B, H, Sq, Sk, D, M = 1, 32, 1, 4096, 128, 640
        Dc = 4 * D
        return {
            "x": _w((lambda *s: torch.randn(*s, dtype=torch.bfloat16) * 0.05)(B, Sq, M)),
            "c_kv": _w((lambda *s: torch.randn(*s, dtype=torch.bfloat16) * 1.6)(B, Sk, Dc)),
            "w_q": _w((lambda *s: torch.randn(*s, dtype=torch.bfloat16) * 0.8)(M, H, D) * (M ** -0.5)),
            "w_uk": _w((lambda *s: torch.randn(*s, dtype=torch.bfloat16) * 0.8)(Dc, H, D) * (Dc ** -0.5)),
            "w_uv": _w((lambda *s: torch.randn(*s, dtype=torch.bfloat16) * 1.6)(Dc, H, D) * (Dc ** -0.5)),
            "w_o": _w((lambda *s: torch.randn(*s, dtype=torch.bfloat16) * 1.6)(H, D, M) * ((H * D) ** -0.5)),
        }
    _A_in = _A_setup()

    def _B_setup():
        B, S, D, F = 1, 1, 640, 1728
        return {
            "x": _w((lambda *s: torch.randn(*s, dtype=torch.bfloat16) * 0.05)(B, S, D)),
            "w1": _w((lambda *s: torch.randn(*s, dtype=torch.bfloat16) * 0.4)(D, F) * (D ** -0.5)),
            "b1": _w((lambda *s: torch.randn(*s, dtype=torch.bfloat16) * 0.4)(F) * 0.01),
            "w2": _w((lambda *s: torch.randn(*s, dtype=torch.bfloat16) * 0.4)(F, D) * (F ** -0.5)),
            "b2": _w((lambda *s: torch.randn(*s, dtype=torch.bfloat16) * 0.4)(D) * 0.01),
        }
    _B_in = _B_setup()

    return {
        "A_x": _A_in["x"],
        "A_c_kv": _A_in["c_kv"],
        "A_w_q": _A_in["w_q"],
        "A_w_uk": _A_in["w_uk"],
        "A_w_uv": _A_in["w_uv"],
        "A_w_o": _A_in["w_o"],
        "B_x": _B_in["x"],
        "B_w1": _B_in["w1"],
        "B_b1": _B_in["b1"],
        "B_w2": _B_in["w2"],
        "B_b2": _B_in["b2"],
    }

def reference(A_x, A_c_kv, A_w_q, A_w_uk, A_w_uv, A_w_o, B_x, B_w1, B_b1, B_w2, B_b2):
    def _A_ref(x, c_kv, w_q, w_uk, w_uv, w_o):
        B, Sq, M = x.shape[0], x.shape[1], x.shape[2]
        Sk = c_kv.shape[1]
        H, D = w_q.shape[1], w_q.shape[2]
        q = torch.einsum("bqm,mhd->bhqd", x, w_q)
        k = torch.einsum("bkc,chd->bhkd", c_kv, w_uk)
        v = torch.einsum("bkc,chd->bhkd", c_kv, w_uv)
        scores = torch.einsum("bhqd,bhkd->bhqk", q, k) * (D ** -0.5)
        off = Sk - Sq
        qi = torch.arange(Sq)[:, None]
        kj = torch.arange(Sk)[None, :]
        cmask = kj <= (qi + off)
        scores = torch.where(cmask[None, None], scores, -1e9)
        p = _softmax(scores, axis=-1)
        ctx = torch.einsum("bhqk,bhkd->bhqd", p, v)
        return torch.einsum("bhqd,hdm->bqm", ctx, w_o)

    def _B_ref(x, w1, b1, w2, b2):
        h = torch.einsum("bsd,df->bsf", x, w1) + b1
        h = _gelu(h)
        return torch.einsum("bsf,fd->bsd", h, w2) + b2

    x = A_x
    x = x + _A_ref(_layernorm(x, axis=-1), A_c_kv, A_w_q, A_w_uk, A_w_uv, A_w_o)
    x = x + _B_ref(_layernorm(x, axis=-1), B_w1, B_b1, B_w2, B_b2)
    x = x + _A_ref(_layernorm(x, axis=-1), A_c_kv, A_w_q, A_w_uk, A_w_uv, A_w_o)
    x = x + _B_ref(_layernorm(x, axis=-1), B_w1, B_b1, B_w2, B_b2)
    return x
```

```asm
; @launch grid=(256,1,1) block=(512,1,1) lds=163840
.amdgcn_target "amdgcn-amd-amdhsa--gfx950"
.text
.globl interleave_layers__compressed_kv_cla__dense_activation_gelu__decode_kernel
.p2align 8
.type interleave_layers__compressed_kv_cla__dense_activation_gelu__decode_kernel,@function
interleave_layers__compressed_kv_cla__dense_activation_gelu__decode_kernel:
    s_cmp_ge_u32 s2, 256
    s_cbranch_scc1 Lend
    s_load_dwordx2 s[32:33], s[0:1], 16
    s_load_dwordx2 s[36:37], s[0:1], 24
    s_load_dwordx2 s[56:57], s[0:1], 104
    s_load_dwordx16 s[4:19], s[0:1], 0
    s_load_dwordx8 s[20:27], s[0:1], 64
    s_load_dwordx4 s[28:31], s[0:1], 96
    v_lshrrev_b32 v1, 6, v0
    v_and_b32 v0, 63, v0
    v_readfirstlane_b32 s66, v1
    s_and_b32 s64, s2, 7
    s_lshr_b32 s65, s2, 3
    s_getpc_b64 s[48:49]
Lpc:
    s_mov_b32 s50, Lcode_end-Lpc
    s_mov_b32 s51, 0x20000
    v_lshl_add_u32 v3, s65, 3, v1
    v_lshlrev_b32 v3, 7, v3
    buffer_load_dword v255, v3, s[48:51], 0 offen
    s_mov_b32 s34, 5242880
    s_mov_b32 s35, 0x20000
    s_mov_b32 s38, 4194304
    s_mov_b32 s39, 0x20000
    s_mov_b32 s58, 8388608
    s_mov_b32 s59, 0x20000
    s_mov_b32 s70, 0
    s_mov_b32 s69, 1
    s_mov_b32 s68, 0
    s_lshl_b32 s82, s64, 5
    s_add_u32 s82, s82, s65
    s_and_b32 s67, s66, 3
    s_lshl_b32 s95, s67, 12
    s_add_u32 s95, s95, 131072
    v_and_b32 v1, 15, v0
    v_lshrrev_b32 v2, 4, v0
    s_cmp_lt_u32 s66, 4
    s_cbranch_scc1 Lproj
Lattn:
    v_lshlrev_b32 v224, 2, v0
    v_add_u32 v224, 158336, v224
    v_mov_b32 v225, 0
    ds_write_b32 v224, v225
    v_mov_b32 v208, -1
    v_mov_b32 v209, -1
    v_mov_b32 v210, -1
    v_mov_b32 v211, -1
    v_lshlrev_b32 v226, 4, v0
    v_lshrrev_b32 v238, 3, v0
    v_and_b32 v239, 7, v0
    v_lshlrev_b32 v239, 7, v239
    v_lshl_add_u32 v238, v238, 13, v239
    s_lshl_b32 s72, s65, 2
    s_add_u32 s72, s72, s67
    s_lshl_b32 s74, s64, 10
    s_lshr_b32 s73, s72, 3
    s_mul_i32 s73, s73, 40
    s_and_b32 s75, s72, 7
    s_mul_i32 s75, s75, 5
    s_add_u32 s73, s73, s75
    s_add_u32 s73, s73, 0
    s_lshl_b32 s73, s73, 13
    s_add_u32 s73, s73, s74
    s_lshl_b32 s72, s72, 15
    s_add_u32 s74, s74, s72
    s_waitcnt lgkmcnt(0)
    s_mov_b32 exec_hi, 0xff
    buffer_load_dword v242, v238, s[32:35], s73 offen
    s_mov_b32 exec_lo, -1
    s_mov_b32 exec_hi, 0
    buffer_load_dword v243, v238, s[36:39], s74 offen
    s_mov_b64 exec, -1
    buffer_load_dword v227, v225, s[56:59], 0 offen sc1
    s_lshl_b32 s16, s2, 2
    s_add_u32 s16, s16, s67
    s_and_b32 s16, s16, 15
    s_lshl_b32 s16, s16, 8
    s_add_u32 s16, s16, 4194304
    s_add_u32 s16, s30, s16
    s_addc_u32 s17, s31, 0
    s_cmp_ge_u32 s2, 4
    s_cbranch_scc1 La_nowarm
    s_load_dword s0, s[16:17], 0 glc
    s_load_dword s1, s[16:17], 0x2000 glc
La_nowarm:
    s_lshl_b32 s76, s64, 15
    s_lshr_b32 s77, s65, 4
    s_lshl_b32 s77, s77, 14
    s_add_u32 s76, s76, s77
    s_and_b32 s77, s65, 15
    s_lshl_b32 s77, s77, 9
    s_add_u32 s76, s76, s77
    s_add_u32 s76, s76, 262144
    s_cmp_lg_u32 s67, 0
    s_cbranch_scc1 La_noqa
    v_lshrrev_b32 v212, 5, v0
    v_mul_u32_u24 v212, 7680, v212
    v_add_u32 v212, v212, v226
    buffer_store_dwordx4 v[208:211], v212, s[56:59], s76 offen sc1
La_noqa:
    s_mov_b64 exec, -1
    s_bfe_u32 s71, s65, 0x20002
    s_lshl_b32 s71, s71, 18
    s_lshl_b32 s77, s64, 15
    s_add_u32 s71, s71, s77
    s_bfe_u32 s77, s65, 0x10001
    s_lshl_b32 s77, s77, 14
    s_add_u32 s71, s71, s77
    s_lshr_b32 s77, s65, 4
    s_lshl_b32 s77, s77, 13
    s_add_u32 s71, s71, s77
    s_and_b32 s77, s65, 1
    s_lshl_b32 s77, s77, 12
    s_add_u32 s71, s71, s77
    s_add_u32 s71, s71, 524288
    s_lshl_b32 s77, s67, 10
    s_add_u32 s75, s71, s77
    v_mov_b32 v212, 2147483648
    s_lshl_b32 s79, s67, 7
    s_add_u32 s79, s79, s76
    s_add_u32 s79, s79, 4194304
    s_mov_b64 exec, 0xff
    v_add_u32 v212, s79, v226
    s_add_u32 s79, s79, 8064
    s_mov_b64 exec, 0xff00
    v_add_u32 v212, s79, v226
    s_bfe_u32 s90, s65, 0x20002
    s_lshl_b32 s90, s90, 15
    s_lshr_b32 s79, s65, 4
    s_lshl_b32 s79, s79, 13
    s_add_u32 s90, s90, s79
    s_lshl_b32 s79, s64, 9
    s_add_u32 s90, s90, s79
    s_and_b32 s79, s65, 3
    s_lshl_b32 s79, s79, 7
    s_add_u32 s90, s90, s79
    s_add_u32 s90, s90, 131072
    s_lshr_b32 s79, s67, 1
    s_lshl_b32 s79, s79, 14
    s_add_u32 s88, s90, s79
    s_and_b32 s79, s67, 1
    s_lshl_b32 s79, s79, 12
    s_add_u32 s88, s88, s79
    s_mul_i32 s78, s82, 2688
    s_mul_i32 s79, s67, 640
    s_add_u32 s78, s78, s79
    s_add_u32 s78, s78, 2096768
    s_mov_b32 exec_lo, 0xff000000
    s_mov_b32 exec_hi, -1
    v_add_u32 v212, s78, v226
    s_lshl_b32 s77, s67, 4
    s_add_u32 s77, s77, s65
    s_sub_u32 s77, s77, 16
    s_cmp_lt_u32 s65, 16
    s_cselect_b32 s77, 100, s77
    s_mul_i32 s78, s64, 1280
    s_lshl_b32 s79, s77, 5
    s_add_u32 s78, s78, s79
    s_add_u32 s78, s78, 81920
    s_cmp_lt_u32 s77, 40
    s_cselect_b32 s78, s78, 2147483648
    s_mov_b64 exec, 0xff0000
    v_bfe_u32 v213, v0, 1, 1
    v_mul_u32_u24 v213, 10240, v213
    v_bfe_u32 v214, v0, 2, 1
    v_mul_u32_u24 v214, 4194304, v214
    v_and_b32 v215, 16, v226
    v_add3_u32 v213, v213, v214, v215
    v_add_u32 v212, s78, v213
    s_lshr_b32 s78, s77, 3
    s_lshl_b32 s78, s78, 14
    s_and_b32 s79, s77, 7
    s_lshl_b32 s79, s79, 10
    s_add_u32 s78, s78, s79
    s_lshl_b32 s79, s64, 7
    s_add_u32 s78, s78, s79
    s_add_u32 s78, s78, 5767168
    s_cmp_lt_u32 s77, 40
    s_cselect_b32 s78, s78, 2147483648
    s_mov_b64 exec, -1
    v_bfe_u32 v213, v0, 3, 2
    v_mul_u32_u24 v213, 81920, v213
    v_lshrrev_b32 v214, 5, v0
    v_lshl_add_u32 v213, v214, 13, v213
    v_and_b32 v215, 112, v226
    v_add3_u32 v213, v213, v215, s78
    v_bfe_u32 v214, v0, 3, 1
    v_mul_u32_u24 v214, 4194304, v214
    v_add3_u32 v214, v214, v215, s88
    s_mov_b64 exec, -1
    buffer_store_dwordx4 v[208:211], v226, s[56:59], s75 offen sc1
    buffer_store_dwordx4 v[208:211], v213, s[56:59], 0 offen sc1
    s_mov_b64 exec, 0xffff
    buffer_store_dwordx4 v[208:211], v214, s[56:59], 0 offen sc1
    s_mov_b64 exec, -1
    buffer_store_dwordx4 v[208:211], v212, s[56:59], 0 offen sc1
    s_barrier
    s_cmp_ge_u32 s2, 4
    s_cbranch_scc1 La_nocal
    s_and_b32 s20, s67, 1
    s_lshl_b32 s21, s20, 13
    s_lshl_b32 s20, s20, 2
    s_add_u32 s20, s20, 131072
    s_waitcnt lgkmcnt(0)
    s_memtime s[24:25]
    s_waitcnt lgkmcnt(0)
    s_load_dword s0, s[16:17], s21 glc
    s_waitcnt lgkmcnt(0)
    s_memtime s[26:27]
    s_waitcnt lgkmcnt(0)
    s_sub_u32 s0, s24, s26
    v_mov_b32 v220, s20
    v_mov_b32 v221, s0
    ds_max_u32 v220, v221 offset:27480
    s_xor_b32 s21, s21, 0x2000
    s_xor_b32 s20, s20, 4
    s_waitcnt lgkmcnt(0)
    s_memtime s[24:25]
    s_waitcnt lgkmcnt(0)
    s_load_dword s0, s[16:17], s21 glc
    s_waitcnt lgkmcnt(0)
    s_memtime s[26:27]
    s_waitcnt lgkmcnt(0)
    s_sub_u32 s0, s24, s26
    v_mov_b32 v220, s20
    v_mov_b32 v221, s0
    ds_max_u32 v220, v221 offset:27480
    s_xor_b32 s21, s21, 0x2000
    s_xor_b32 s20, s20, 4
    s_lshl_b32 s20, s67, 2
    s_add_u32 s20, s20, 131072
    v_mov_b32 v220, s20
    v_mov_b32 v221, 1
    ds_write_b32 v220, v221 offset:27488
La_nocal:
    s_mov_b32 s40, s12
    s_mov_b32 s41, s13
    s_mov_b32 s42, 4194304
    s_mov_b32 s43, 0x20000
    s_mov_b32 s60, s6
    s_mov_b32 s61, s7
    s_mov_b32 s62, 4194304
    s_mov_b32 s63, 0x20000
    s_mov_b32 s48, s18
    s_mov_b32 s49, s19
    s_mov_b32 s50, 2211840
    s_mov_b32 s51, 0x20000
    s_mov_b32 s52, s22
    s_mov_b32 s53, s23
    s_mov_b32 s54, 2211840
    s_mov_b32 s55, 0x20000
    v_lshlrev_b32 v236, 2, v2
    v_xor_b32 v236, v236, v1
    v_lshlrev_b32 v236, 4, v236
    v_lshl_add_u32 v236, v2, 10, v236
    s_and_b32 s78, s65, 3
    s_lshl_b32 s80, s64, 2
    s_add_u32 s80, s80, s78
    s_lshl_b32 s84, s80, 17
    s_lshl_b32 s75, s67, 8
    s_add_u32 s84, s84, s75
    s_lshl_b32 s85, s67, 15
    s_getreg_b32 s81, hwreg(HW_REG_XCC_ID)
    s_and_b32 s81, s81, 15
    v_xor_b32 v216, v1, v2
    v_lshlrev_b32 v3, 4, v216
    v_lshl_add_u32 v3, v2, 9, v3
    s_lshr_b32 s72, s65, 2
    s_lshl_b32 s77, s72, 12
    s_add_u32 s77, s77, 32768
    s_lshl_b32 s72, s72, 15
    s_lshr_b32 s78, s64, 2
    s_lshl_b32 s78, s78, 13
    s_add_u32 s72, s72, s78
    s_lshr_b32 s78, s67, 1
    s_lshl_b32 s78, s78, 11
    s_add_u32 s72, s72, s78
    s_and_b32 s78, s67, 1
    s_lshl_b32 s78, s78, 8
    s_add_u32 s72, s72, s78
    s_add_u32 s72, s72, 262144
    v_add_u32 v3, s72, v3
    v_lshlrev_b32 v4, 4, v1
    v_lshl_add_u32 v4, v2, 10, v4
    s_add_u32 s72, s71, s75
    v_add_u32 v4, s72, v4
    v_lshl_add_u32 v6, v1, 2, v2
    v_lshlrev_b32 v6, 4, v6
    v_add_u32 v6, 131072, v6
    v_and_b32 v218, 1, v2
    v_bfe_u32 v217, v2, 1, 1
    v_lshl_add_u32 v217, v218, 1, v217
    v_and_b32 v218, 12, v2
    v_or_b32 v217, v217, v218
    v_bfe_u32 v218, v1, 1, 1
    v_xor_b32 v217, v217, v218
    v_and_b32 v218, 12, v1
    v_xor_b32 v217, v217, v218
    v_lshlrev_b32 v7, 4, v217
    v_lshl_add_u32 v7, v2, 11, v7
    v_lshl_add_u32 v7, v218, 6, v7
    v_and_b32 v218, 1, v1
    v_lshl_add_u32 v7, v218, 3, v7
    v_add_u32 v7, s85, v7
    v_xor_b32 v8, 32, v7
    v_xor_b32 v9, 64, v7
    v_xor_b32 v10, 96, v7
    v_xor_b32 v11, 128, v7
    v_xor_b32 v12, 160, v7
    v_xor_b32 v13, 192, v7
    v_xor_b32 v14, 224, v7
    v_and_b32 v218, 1, v1
    v_bfe_u32 v217, v1, 1, 1
    v_lshl_add_u32 v217, v218, 1, v217
    v_and_b32 v218, 12, v1
    v_or_b32 v217, v217, v218
    v_and_b32 v217, 3, v217
    v_lshrrev_b32 v218, 2, v1
    v_lshlrev_b32 v5, 8, v2
    v_lshl_add_u32 v5, v217, 4, v5
    v_lshl_add_u32 v5, v218, 1, v5
    s_lshl_b32 s72, s67, 6
    s_add_u32 s72, s72, 131072
    v_add_u32 v5, s72, v5
    v_lshl_add_u32 v217, v217, 3, v218
    v_lshlrev_b32 v244, 4, v216
    v_lshl_add_u32 v244, v217, 8, v244
    s_mul_i32 s72, s67, 40960
    v_add_u32 v244, s72, v244
    v_xor_b32 v245, 64, v244
    v_xor_b32 v246, 128, v244
    v_xor_b32 v247, 192, v244
    v_and_b32 v248, 31, v0
    v_lshlrev_b32 v248, 7, v248
    v_add_u32 v249, s77, v248
    s_xor_b32 s72, s82, 16
    s_lshl_b32 s72, s72, 7
    s_add_u32 s72, s72, 32768
    s_mov_b32 exec_lo, 0
    v_add_u32 v249, 4096, v248
    s_mov_b32 exec_hi, 16
    v_mov_b32 v249, s72
    s_mov_b64 exec, -1
    v_lshlrev_b32 v216, 4, v216
    v_lshl_add_u32 v1, v1, 8, v216
    v_add_u32 v1, s95, v1
    s_lshl_b32 s72, s67, 2
    s_add_u32 s72, s72, 131072
    v_mov_b32 v0, s72
    s_lshl_b32 s79, s82, 7
    s_add_u32 s79, s79, 32768
    v_xor_b32 v229, 64, v3
    v_add_u32 v229, 3072, v229
    v_xor_b32 v233, 64, v1
    v_xor_b32 v230, 128, v3
    v_add_u32 v230, 14336, v230
    v_xor_b32 v234, 128, v1
    v_xor_b32 v231, 192, v3
    v_add_u32 v231, 17408, v231
    v_xor_b32 v235, 192, v1
    v_mov_b32 v237, s69
    v_mov_b32 v232, v1
    s_mov_b32 s3, 2
    s_lshl_b32 s0, s2, 2
    s_add_u32 s0, s0, s67
    s_and_b32 s0, s0, 0xfffffff3
    s_cmp_eq_u32 s0, 3
    s_cbranch_scc1 La_dec
La_dec_back:
    s_waitcnt vmcnt(4)
    v_readfirstlane_b32 s91, v227
    s_nop 0
    s_add_u32 s91, s91, 1
    s_mul_i32 s87, s91, 0x9e3779b1
    s_cmp_lg_u32 s67, 0
    s_cbranch_scc1 La_noflag
    v_mov_b32 v216, s91
    ds_write_b32 v0, v216 offset:27412
    ds_write_b32 v0, v237 offset:27408
La_noflag:
    s_xor_b32 s72, s87, s81
    v_mov_b32 v217, s72
    s_lshl_b32 s72, s67, 2
    s_add_u32 s79, s79, s72
    s_cmp_lt_u32 s3, 2
    s_cbranch_scc1 La_pub
    s_waitcnt vmcnt(0)
La_pub_back2:
    s_mov_b64 exec, 1
    buffer_store_dword v217, v225, s[56:59], s79 offen sc1
    s_mov_b64 exec, -1
    s_lshr_b32 s72, s65, 2
    s_lshl_b32 s72, s72, 14
    s_lshl_b32 s73, s80, 17
    s_add_u32 s72, s72, s73
    s_lshl_b32 s73, s67, 12
    s_add_u32 s72, s72, s73
Ll136:
    ds_read_b32 v216, v0 offset:27360
    s_add_u32 s70, s70, 1
    s_cmp_ge_u32 s70, 4194304
    s_cbranch_scc1 Lok37
    s_waitcnt lgkmcnt(0)
    v_cmp_eq_u32 vcc, 0, v216
    s_cbranch_vccnz Ll136
Lok37:
    s_mov_b32 m0, s85
    s_mov_b32 exec_hi, 0
    buffer_load_dword v242, v248, s[60:63], s72 offen
    s_mov_b32 exec_lo, 0x08080808
    buffer_load_dword v243, v238, s[40:43], s74 offen
    s_mov_b32 exec_lo, -1
    s_mov_b32 s44, s14
    s_mov_b32 s45, s15
    s_mov_b32 s46, 5242880
    s_mov_b32 s47, 0x20000
    s_mul_i32 s72, s82, 20480
    s_mul_i32 s73, s67, 5120
    s_add_u32 s72, s72, s73
    s_mov_b32 exec_lo, 0xffffffff
    buffer_load_dword v242, v248, s[44:47], s72 offen
    s_mov_b32 exec_lo, -1
    s_mov_b32 exec_hi, -1
    v_xor_b32 v240, 0, v236
    buffer_load_dwordx4 v240, s[60:63], s84 offen  lds
    s_add_u32 m0, m0, 1024
    s_add_u32 s84, s84, 4096
    buffer_load_dwordx4 v240, s[60:63], s84 offen  lds
    s_add_u32 m0, m0, 1024
    s_add_u32 s84, s84, 4096
    v_xor_b32 v241, 32, v236
    buffer_load_dwordx4 v241, s[60:63], s84 offen  lds
    s_add_u32 m0, m0, 1024
    s_add_u32 s84, s84, 4096
    buffer_load_dwordx4 v241, s[60:63], s84 offen  lds
    s_add_u32 m0, m0, 1024
    s_add_u32 s84, s84, 4096
    v_xor_b32 v240, 16, v236
    buffer_load_dwordx4 v240, s[60:63], s84 offen  lds
    s_add_u32 m0, m0, 1024
    s_add_u32 s84, s84, 4096
    buffer_load_dwordx4 v240, s[60:63], s84 offen  lds
    s_add_u32 m0, m0, 1024
    s_add_u32 s84, s84, 4096
    v_xor_b32 v241, 48, v236
    buffer_load_dwordx4 v241, s[60:63], s84 offen  lds
    s_add_u32 m0, m0, 1024
    s_add_u32 s84, s84, 4096
    buffer_load_dwordx4 v241, s[60:63], s84 offen  lds
    s_add_u32 m0, m0, 1024
    s_add_u32 s84, s84, 4096
    v_xor_b32 v240, 0, v236
    buffer_load_dwordx4 v240, s[60:63], s84 offen  lds
    s_add_u32 m0, m0, 1024
    s_add_u32 s84, s84, 4096
    buffer_load_dwordx4 v240, s[60:63], s84 offen  lds
    s_add_u32 m0, m0, 1024
    s_add_u32 s84, s84, 4096
    v_xor_b32 v241, 32, v236
    buffer_load_dwordx4 v241, s[60:63], s84 offen  lds
    s_add_u32 m0, m0, 1024
    s_add_u32 s84, s84, 4096
    buffer_load_dwordx4 v241, s[60:63], s84 offen  lds
    s_add_u32 m0, m0, 1024
    s_add_u32 s84, s84, 4096
    v_xor_b32 v240, 16, v236
    buffer_load_dwordx4 v240, s[60:63], s84 offen  lds
    s_add_u32 m0, m0, 1024
    s_add_u32 s84, s84, 4096
    buffer_load_dwordx4 v240, s[60:63], s84 offen  lds
    s_add_u32 m0, m0, 1024
    s_add_u32 s84, s84, 4096
    v_xor_b32 v241, 48, v236
    buffer_load_dwordx4 v241, s[60:63], s84 offen  lds
    s_add_u32 m0, m0, 1024
    s_add_u32 s84, s84, 4096
    buffer_load_dwordx4 v241, s[60:63], s84 offen  lds
    s_add_u32 m0, m0, 1024
    s_add_u32 s84, s84, 4096
    v_mov_b32 v220, 131072
Llw38:
    ds_read_b128 v[216:219], v220 offset:27392
    s_add_u32 s70, s70, 1
    s_cmp_ge_u32 s70, 4194304
    s_cbranch_scc1 Lok39
    s_waitcnt lgkmcnt(0)
    v_min3_u32 v216, v216, v217, v218
    v_min_u32 v216, v216, v219
    v_cmp_gt_u32 vcc, s69, v216
    s_cbranch_vccnz Llw38
Lok39:
    v_xor_b32 v240, 0, v236
    buffer_load_dwordx4 v240, s[60:63], s84 offen  lds
    s_add_u32 m0, m0, 1024
    s_add_u32 s84, s84, 4096
    buffer_load_dwordx4 v240, s[60:63], s84 offen  lds
    s_add_u32 m0, m0, 1024
    s_add_u32 s84, s84, 4096
    v_xor_b32 v241, 32, v236
    buffer_load_dwordx4 v241, s[60:63], s84 offen  lds
    s_add_u32 m0, m0, 1024
    s_add_u32 s84, s84, 4096
    buffer_load_dwordx4 v241, s[60:63], s84 offen  lds
    s_add_u32 m0, m0, 1024
    s_add_u32 s84, s84, 4096
    s_mov_b32 exec_hi, 31
    buffer_load_dwordx4 v[252:255], v249, s[56:59], 0 offen sc1
    s_mov_b32 exec_hi, -1
    v_xor_b32 v240, 16, v236
    buffer_load_dwordx4 v240, s[60:63], s84 offen  lds
    s_add_u32 m0, m0, 1024
    s_add_u32 s84, s84, 4096
    buffer_load_dwordx4 v240, s[60:63], s84 offen  lds
    s_add_u32 m0, m0, 1024
    s_add_u32 s84, s84, 4096
    v_xor_b32 v241, 48, v236
    buffer_load_dwordx4 v241, s[60:63], s84 offen  lds
    s_add_u32 m0, m0, 1024
    s_add_u32 s84, s84, 4096
    buffer_load_dwordx4 v241, s[60:63], s84 offen  lds
    s_add_u32 m0, m0, 1024
    s_add_u32 s84, s84, 4096
    v_xor_b32 v240, 0, v236
    buffer_load_dwordx4 v240, s[60:63], s84 offen  lds
    s_add_u32 m0, m0, 1024
    s_add_u32 s84, s84, 4096
    buffer_load_dwordx4 v240, s[60:63], s84 offen  lds
    s_add_u32 m0, m0, 1024
    s_add_u32 s84, s84, 4096
    v_xor_b32 v241, 32, v236
    buffer_load_dwordx4 v241, s[60:63], s84 offen  lds
    s_add_u32 m0, m0, 1024
    s_add_u32 s84, s84, 4096
    buffer_load_dwordx4 v241, s[60:63], s84 offen  lds
    s_add_u32 m0, m0, 1024
    s_add_u32 s84, s84, 4096
    v_xor_b32 v240, 16, v236
    buffer_load_dwordx4 v240, s[60:63], s84 offen  lds
    s_add_u32 m0, m0, 1024
    s_add_u32 s84, s84, 4096
    buffer_load_dwordx4 v240, s[60:63], s84 offen  lds
    s_add_u32 m0, m0, 1024
    s_add_u32 s84, s84, 4096
    v_xor_b32 v241, 48, v236
    buffer_load_dwordx4 v241, s[60:63], s84 offen  lds
    s_add_u32 m0, m0, 1024
    s_add_u32 s84, s84, 4096
    buffer_load_dwordx4 v241, s[60:63], s84 offen  lds
    s_waitcnt vmcnt(12)
    s_mov_b32 exec_hi, 31
La_fl:
    v_xor_b32 v252, s87, v252
    v_xor_b32 v253, s87, v253
    v_xor_b32 v254, s87, v254
    v_xor_b32 v255, s87, v255
    v_max3_u32 v252, v252, v253, v254
    v_max_u32 v252, v252, v255
    v_cmp_lt_u32 vcc, 15, v252
    s_cbranch_vccnz La_flre
La_flok:
    v_cmp_eq_u32 vcc, 1, v252
    s_mov_b32 exec_hi, -1
    s_and_b32 s72, vcc_hi, 15
    s_lshl_b32 s72, s72, 13
    v_mov_b32 v216, s72
    v_mov_b32 v217, 131072
    ds_write_b32 v217, v216 offset:27472
    s_and_b32 s73, s64, 3
    s_lshr_b32 s73, s72, s73
    s_and_b32 s73, s73, 0x2000
    v_xor_b32 v3, s73, v3
    s_bfe_u32 s73, s65, 0x20002
    s_lshr_b32 s73, s72, s73
    s_and_b32 s73, s73, 0x2000
    v_xor_b32 v4, s73, v4
    s_xor_b32 s90, s90, s73
    v_xor_b32 v229, 64, v3
    v_add_u32 v229, 3072, v229
    v_xor_b32 v233, 64, v1
    v_xor_b32 v230, 128, v3
    v_add_u32 v230, 14336, v230
    v_xor_b32 v234, 128, v1
    v_xor_b32 v231, 192, v3
    v_add_u32 v231, 17408, v231
    v_xor_b32 v235, 192, v1
    v_mov_b32 v237, s69
    v_mov_b32 v232, v1
    v_mov_b32 v236, 131072
    s_cmp_eq_u32 s67, 0
    s_cselect_b32 s84, 0x00010001, 0
    s_mov_b32 s85, s84
Llw40:
    ds_read_b128 v[208:211], v236 offset:27328
    s_add_u32 s70, s70, 1
    s_cmp_ge_u32 s70, 4194304
    s_cbranch_scc1 Lok41
    s_waitcnt lgkmcnt(0)
    v_min3_u32 v208, v208, v209, v210
    v_min_u32 v208, v208, v211
    v_cmp_gt_u32 vcc, s69, v208
    s_cbranch_vccnz Llw40
Lok41:
    s_mov_b32 m0, s95
    s_nop 0
    buffer_load_dwordx4 v3, s[56:59], s68 offen offset:0 sc1 lds
    buffer_load_dwordx4 v229, s[56:59], s68 offen offset:1024 sc1 lds
    buffer_load_dwordx4 v230, s[56:59], s68 offen offset:2048 sc1 lds
    buffer_load_dwordx4 v231, s[56:59], s68 offen offset:3072 sc1 lds
    ds_write_b32 v0, v237 offset:27376
    s_waitcnt vmcnt(4)
    ds_write_b32 v0, v237 offset:27456
    ds_read_b128 v[16:19], v244 offset:0
    ds_read_b128 v[20:23], v244 offset:1024
    ds_read_b128 v[24:27], v245 offset:0
    ds_read_b128 v[28:31], v245 offset:1024
    ds_read_b128 v[32:35], v246 offset:0
    ds_read_b128 v[36:39], v246 offset:1024
    ds_read_b128 v[40:43], v247 offset:0
    ds_read_b128 v[44:47], v247 offset:1024
    ds_read_b64_tr_b16 v[144:145], v7 offset:0
    ds_read_b64_tr_b16 v[146:147], v7 offset:1024
    ds_read_b64_tr_b16 v[148:149], v7 offset:8192
    ds_read_b64_tr_b16 v[150:151], v7 offset:9216
    ds_read_b64_tr_b16 v[152:153], v7 offset:16384
    ds_read_b64_tr_b16 v[154:155], v7 offset:17408
    ds_read_b64_tr_b16 v[156:157], v7 offset:24576
    ds_read_b64_tr_b16 v[158:159], v7 offset:25600
    ds_read_b64_tr_b16 v[160:161], v8 offset:0
    ds_read_b64_tr_b16 v[162:163], v8 offset:1024
    ds_read_b64_tr_b16 v[164:165], v8 offset:8192
    ds_read_b64_tr_b16 v[166:167], v8 offset:9216
    ds_read_b64_tr_b16 v[168:169], v8 offset:16384
    ds_read_b64_tr_b16 v[170:171], v8 offset:17408
    ds_read_b64_tr_b16 v[172:173], v8 offset:24576
    ds_read_b64_tr_b16 v[174:175], v8 offset:25600
    ds_read_b64_tr_b16 v[176:177], v9 offset:0
    ds_read_b64_tr_b16 v[178:179], v9 offset:1024
    ds_read_b64_tr_b16 v[180:181], v9 offset:8192
    ds_read_b64_tr_b16 v[182:183], v9 offset:9216
    ds_read_b64_tr_b16 v[184:185], v9 offset:16384
    ds_read_b64_tr_b16 v[186:187], v9 offset:17408
    ds_read_b64_tr_b16 v[188:189], v9 offset:24576
    ds_read_b64_tr_b16 v[190:191], v9 offset:25600
    ds_read_b64_tr_b16 v[192:193], v10 offset:0
    ds_read_b64_tr_b16 v[194:195], v10 offset:1024
    ds_read_b64_tr_b16 v[196:197], v10 offset:8192
    ds_read_b64_tr_b16 v[198:199], v10 offset:9216
    ds_read_b64_tr_b16 v[200:201], v10 offset:16384
    ds_read_b64_tr_b16 v[202:203], v10 offset:17408
    ds_read_b64_tr_b16 v[204:205], v10 offset:24576
    ds_read_b64_tr_b16 v[206:207], v10 offset:25600
Llw42:
    ds_read_b128 v[208:211], v236 offset:27456
    s_add_u32 s70, s70, 1
    s_cmp_ge_u32 s70, 4194304
    s_cbranch_scc1 Lok43
    s_waitcnt lgkmcnt(0)
    v_min3_u32 v208, v208, v209, v210
    v_min_u32 v208, v208, v211
    v_cmp_gt_u32 vcc, s69, v208
    s_cbranch_vccnz Llw42
Lok43:
    v_mov_b32 v7, v244
    v_lshrrev_b32 v9, 1, v2
    v_and_b32 v10, 1, v2
    v_lshlrev_b32 v9, 14, v9
    v_lshl_add_u32 v9, v10, 12, v9
    v_xor_b32 v244, 32768, v244
    v_xor_b32 v245, 32768, v245
    v_xor_b32 v246, 32768, v246
    v_xor_b32 v247, 32768, v247
    ds_read_b128 v[48:51], v244 offset:0
    ds_read_b128 v[52:55], v244 offset:1024
    ds_read_b128 v[56:59], v245 offset:0
    ds_read_b128 v[60:63], v245 offset:1024
    ds_read_b128 v[64:67], v246 offset:0
    ds_read_b128 v[68:71], v246 offset:1024
    ds_read_b128 v[72:75], v247 offset:0
    ds_read_b128 v[76:79], v247 offset:1024
    v_xor_b32 v244, 98304, v244
    v_xor_b32 v245, 98304, v245
    v_xor_b32 v246, 98304, v246
    v_xor_b32 v247, 98304, v247
    ds_read_b128 v[80:83], v244 offset:0
    ds_read_b128 v[84:87], v244 offset:1024
    ds_read_b128 v[88:91], v245 offset:0
    ds_read_b128 v[92:95], v245 offset:1024
    ds_read_b128 v[96:99], v246 offset:0
    ds_read_b128 v[100:103], v246 offset:1024
    ds_read_b128 v[104:107], v247 offset:0
    ds_read_b128 v[108:111], v247 offset:1024
    v_xor_b32 v244, 32768, v244
    v_xor_b32 v245, 32768, v245
    v_xor_b32 v246, 32768, v246
    v_xor_b32 v247, 32768, v247
    ds_read_b128 v[112:115], v244 offset:0
    ds_read_b128 v[116:119], v244 offset:1024
    ds_read_b128 v[120:123], v245 offset:0
    ds_read_b128 v[124:127], v245 offset:1024
    ds_read_b128 v[128:131], v246 offset:0
    ds_read_b128 v[132:135], v246 offset:1024
    ds_read_b128 v[136:139], v247 offset:0
    ds_read_b128 v[140:143], v247 offset:1024
    v_bfe_u32 v236, v6, 6, 2
    v_lshlrev_b32 v236, 2, v236
    v_add_u32 v236, 131072, v236
    v_lshl_add_u32 v238, v2, 4, v0
    s_setprio 1
    s_branch La_chk
    .p2align 6
La_loop:
    v_xor_b32 v8, 0, v7
    ds_read_b128 v[16:19], v8 offset:0
    ds_read_b128 v[20:23], v8 offset:1024
    v_xor_b32 v8, 64, v7
    ds_read_b128 v[24:27], v8 offset:0
    ds_read_b128 v[28:31], v8 offset:1024
    v_xor_b32 v8, 128, v7
    ds_read_b128 v[32:35], v8 offset:0
    ds_read_b128 v[36:39], v8 offset:1024
    v_xor_b32 v8, 192, v7
    ds_read_b128 v[40:43], v8 offset:0
    ds_read_b128 v[44:47], v8 offset:1024
    v_xor_b32 v8, 32768, v7
    ds_read_b128 v[48:51], v8 offset:0
    ds_read_b128 v[52:55], v8 offset:1024
    v_xor_b32 v8, 32832, v7
    ds_read_b128 v[56:59], v8 offset:0
    ds_read_b128 v[60:63], v8 offset:1024
    v_xor_b32 v8, 32896, v7
    ds_read_b128 v[64:67], v8 offset:0
    ds_read_b128 v[68:71], v8 offset:1024
    v_xor_b32 v8, 32960, v7
    ds_read_b128 v[72:75], v8 offset:0
    ds_read_b128 v[76:79], v8 offset:1024
    v_xor_b32 v229, 64, v3
    v_add_u32 v229, 3072, v229
    v_xor_b32 v233, 64, v1
    v_xor_b32 v230, 128, v3
    v_add_u32 v230, 14336, v230
    v_xor_b32 v234, 128, v1
    v_xor_b32 v231, 192, v3
    v_add_u32 v231, 17408, v231
    v_xor_b32 v235, 192, v1
    v_mov_b32 v237, s69
    v_mov_b32 v232, v1
    v_bfe_u32 v236, v6, 6, 2
    v_lshlrev_b32 v236, 2, v236
    v_add_u32 v236, 131072, v236
    v_lshl_add_u32 v238, v2, 4, v0
    s_barrier
    s_sleep 7
La_h1:
    s_mov_b32 m0, s95
    s_nop 0
    buffer_load_dwordx4 v3, s[56:59], s68 offen offset:0 sc1 lds
    buffer_load_dwordx4 v229, s[56:59], s68 offen offset:1024 sc1 lds
    buffer_load_dwordx4 v230, s[56:59], s68 offen offset:2048 sc1 lds
    buffer_load_dwordx4 v231, s[56:59], s68 offen offset:3072 sc1 lds
La_chk:
    s_add_u32 s72, s68, s90
    s_add_u32 s70, s70, 1
    s_cmp_ge_u32 s70, 4194304
    s_cbranch_scc1 Lok44
    s_waitcnt vmcnt(0)
    ds_read_b128 v[208:211], v232
    ds_read_b128 v[212:215], v233
    ds_read_b128 v[216:219], v234
    ds_read_b128 v[220:223], v235
    s_waitcnt lgkmcnt(0)
    v_max3_u32 v224, v208, v212, v216
    v_max_u32 v224, v224, v220
    v_cmp_eq_u32 vcc, -1, v224
    s_cbranch_vccnz La_h1
Lok44:
    ds_write_b32 v0, v237 offset:27344
    v_mfma_f32_16x16x32_bf16 v[224:227], v[208:211], v[16:19], 0
    v_xor_b32 v232, 4096, v232
    v_xor_b32 v233, 4096, v233
    v_mfma_f32_16x16x32_bf16 v[228:231], v[208:211], v[20:23], 0
    v_xor_b32 v234, 4096, v234
    v_xor_b32 v235, 4096, v235
    ds_read_b32 v239, v236 offset:27344
    v_mfma_f32_16x16x32_bf16 v[224:227], v[212:215], v[24:27], v[224:227]
    ds_read_b128 v[240:243], v232
    v_mfma_f32_16x16x32_bf16 v[228:231], v[212:215], v[28:31], v[228:231]
    ds_read_b128 v[244:247], v233
    v_mfma_f32_16x16x32_bf16 v[224:227], v[216:219], v[32:35], v[224:227]
    ds_read_b128 v[248:251], v234
    v_mfma_f32_16x16x32_bf16 v[228:231], v[216:219], v[36:39], v[228:231]
    ds_read_b128 v[252:255], v235
    v_mfma_f32_16x16x32_bf16 v[224:227], v[220:223], v[40:43], v[224:227]
    v_mfma_f32_16x16x32_bf16 v[228:231], v[220:223], v[44:47], v[228:231]
La_fh:
    s_waitcnt lgkmcnt(4)
    v_cmp_gt_u32 vcc, s69, v239
    s_cbranch_vccnz La_fhr
La_fhk:
    s_waitcnt lgkmcnt(3)
    v_mfma_f32_16x16x32_bf16 v[224:227], v[240:243], v[48:51], v[224:227]
    v_xor_b32 v232, 12288, v232
    v_xor_b32 v233, 12288, v233
    v_mfma_f32_16x16x32_bf16 v[228:231], v[240:243], v[52:55], v[228:231]
    v_xor_b32 v234, 12288, v234
    v_xor_b32 v235, 12288, v235
    s_waitcnt lgkmcnt(0)
    ds_read_b128 v[208:211], v232
    ds_read_b128 v[212:215], v233
    ds_read_b128 v[216:219], v234
    ds_read_b128 v[220:223], v235
    v_mfma_f32_16x16x32_bf16 v[224:227], v[244:247], v[56:59], v[224:227]
    v_mfma_f32_16x16x32_bf16 v[228:231], v[244:247], v[60:63], v[228:231]
    v_mfma_f32_16x16x32_bf16 v[224:227], v[248:251], v[64:67], v[224:227]
    v_mfma_f32_16x16x32_bf16 v[228:231], v[248:251], v[68:71], v[228:231]
    v_mfma_f32_16x16x32_bf16 v[224:227], v[252:255], v[72:75], v[224:227]
    v_mfma_f32_16x16x32_bf16 v[228:231], v[252:255], v[76:79], v[228:231]
    s_waitcnt lgkmcnt(3)
    v_mfma_f32_16x16x32_bf16 v[224:227], v[208:211], v[80:83], v[224:227]
    v_xor_b32 v232, 4096, v232
    v_xor_b32 v233, 4096, v233
    v_mfma_f32_16x16x32_bf16 v[228:231], v[208:211], v[84:87], v[228:231]
    v_xor_b32 v234, 4096, v234
    v_xor_b32 v235, 4096, v235
    s_waitcnt lgkmcnt(0)
    ds_read_b128 v[240:243], v232
    ds_read_b128 v[244:247], v233
    ds_read_b128 v[248:251], v234
    ds_read_b128 v[252:255], v235
    v_mfma_f32_16x16x32_bf16 v[224:227], v[212:215], v[88:91], v[224:227]
    ds_read_b64_tr_b16 v[16:17], v11 offset:0
    ds_read_b64_tr_b16 v[18:19], v11 offset:1024
    v_mfma_f32_16x16x32_bf16 v[228:231], v[212:215], v[92:95], v[228:231]
    ds_read_b64_tr_b16 v[20:21], v11 offset:8192
    ds_read_b64_tr_b16 v[22:23], v11 offset:9216
    v_mfma_f32_16x16x32_bf16 v[224:227], v[216:219], v[96:99], v[224:227]
    ds_read_b64_tr_b16 v[24:25], v11 offset:16384
    ds_read_b64_tr_b16 v[26:27], v11 offset:17408
    v_mfma_f32_16x16x32_bf16 v[228:231], v[216:219], v[100:103], v[228:231]
    ds_read_b64_tr_b16 v[28:29], v11 offset:24576
    ds_read_b64_tr_b16 v[30:31], v11 offset:25600
    v_mfma_f32_16x16x32_bf16 v[224:227], v[220:223], v[104:107], v[224:227]
    ds_read_b64_tr_b16 v[32:33], v12 offset:0
    ds_read_b64_tr_b16 v[34:35], v12 offset:1024
    v_mfma_f32_16x16x32_bf16 v[228:231], v[220:223], v[108:111], v[228:231]
    ds_read_b64_tr_b16 v[36:37], v12 offset:8192
    ds_read_b64_tr_b16 v[38:39], v12 offset:9216
    s_waitcnt lgkmcnt(12)
    v_mfma_f32_16x16x32_bf16 v[224:227], v[240:243], v[112:115], v[224:227]
    ds_read_b64_tr_b16 v[40:41], v12 offset:16384
    ds_read_b64_tr_b16 v[42:43], v12 offset:17408
    v_mfma_f32_16x16x32_bf16 v[228:231], v[240:243], v[116:119], v[228:231]
    ds_read_b64_tr_b16 v[44:45], v12 offset:24576
    ds_read_b64_tr_b16 v[46:47], v12 offset:25600
    v_mfma_f32_16x16x32_bf16 v[224:227], v[244:247], v[120:123], v[224:227]
    ds_read_b64_tr_b16 v[48:49], v13 offset:0
    ds_read_b64_tr_b16 v[50:51], v13 offset:1024
    v_mfma_f32_16x16x32_bf16 v[228:231], v[244:247], v[124:127], v[228:231]
    ds_read_b64_tr_b16 v[52:53], v13 offset:8192
    ds_read_b64_tr_b16 v[54:55], v13 offset:9216
    v_mfma_f32_16x16x32_bf16 v[224:227], v[248:251], v[128:131], v[224:227]
    ds_read_b64_tr_b16 v[56:57], v13 offset:16384
    ds_read_b64_tr_b16 v[58:59], v13 offset:17408
    v_mfma_f32_16x16x32_bf16 v[228:231], v[248:251], v[132:135], v[228:231]
    ds_read_b64_tr_b16 v[60:61], v13 offset:24576
    ds_read_b64_tr_b16 v[62:63], v13 offset:25600
    v_mfma_f32_16x16x32_bf16 v[224:227], v[252:255], v[136:139], v[224:227]
    ds_read_b64_tr_b16 v[64:65], v14 offset:0
    ds_read_b64_tr_b16 v[66:67], v14 offset:1024
    v_mfma_f32_16x16x32_bf16 v[228:231], v[252:255], v[140:143], v[228:231]
    ds_read_b64_tr_b16 v[68:69], v14 offset:8192
    ds_read_b64_tr_b16 v[70:71], v14 offset:9216
    ds_read_b64_tr_b16 v[72:73], v14 offset:16384
    ds_read_b64_tr_b16 v[74:75], v14 offset:17408
    ds_read_b64_tr_b16 v[76:77], v14 offset:24576
    ds_read_b64_tr_b16 v[78:79], v14 offset:25600
    s_mov_b32 s73, 0x3e0293ee
    v_lshlrev_b32 v239, 4, v2
    v_add_u32 v239, 131072, v239
    v_mov_b32 v240, 0x3f803f80
    v_mov_b32 v241, 0x3f803f80
    v_mov_b32 v242, 0x3f803f80
    v_mov_b32 v243, 0x3f803f80
    v_pk_add_f32 v[224:225], v[224:225], v[226:227]
    v_pk_add_f32 v[228:229], v[228:229], v[230:231]
    v_add_f32 v224, v224, v225
    v_add_f32 v225, v228, v229
    v_max_f32 v226, v224, v225
    s_nop 1
    v_max_f32_dpp v226, v226, v226 row_ror:8 row_mask:0xf bank_mask:0xf
    s_nop 1
    v_max_f32_dpp v226, v226, v226 row_ror:4 row_mask:0xf bank_mask:0xf
    s_nop 1
    v_max_f32_dpp v226, v226, v226 row_ror:2 row_mask:0xf bank_mask:0xf
    s_nop 1
    v_max_f32_dpp v226, v226, v226 row_ror:1 row_mask:0xf bank_mask:0xf
    v_mul_f32 v226, s73, v226
    v_fma_f32 v224, v224, s73, -v226
    v_fma_f32 v225, v225, s73, -v226
    v_exp_f32 v224, v224
    v_exp_f32 v225, v225
    ds_write_b32 v238, v226 offset:29056
    v_cvt_pk_bf16_f32 v224, v224, v225
    ds_write_b16 v5, v224 offset:28032
    ds_write_b16_d16_hi v5, v224 offset:28040
    ds_write_b32 v0, v237 offset:27280
Lf245:
    ds_read_b32 v208, v236 offset:27280
    ds_read_b128 v[216:219], v6 offset:28032
    ds_read_b128 v[220:223], v239 offset:29056
    s_add_u32 s70, s70, 1
    s_cmp_ge_u32 s70, 4194304
    s_cbranch_scc1 Lok46
    s_waitcnt lgkmcnt(2)
    v_cmp_gt_u32 vcc, s69, v208
    s_cbranch_vccnz Lf245
Lok46:
    s_waitcnt lgkmcnt(1)
    v_mfma_f32_16x16x32_bf16 v[244:247], v[216:219], v[240:243], 0
    v_mfma_f32_16x16x32_bf16 v[224:227], v[216:219], v[144:147], 0
    s_waitcnt lgkmcnt(0)
    v_max3_f32 v212, v220, v221, v222
    v_max_f32 v212, v212, v223
    v_mfma_f32_16x16x32_bf16 v[228:231], v[216:219], v[148:151], 0
    v_pk_add_f32 v[220:221], v[220:221], v[212:213] op_sel_hi:[1,0] neg_lo:[0,1] neg_hi:[0,1]
    v_pk_add_f32 v[222:223], v[222:223], v[212:213] op_sel_hi:[1,0] neg_lo:[0,1] neg_hi:[0,1]
    v_exp_f32 v220, v220
    v_mfma_f32_16x16x32_bf16 v[232:235], v[216:219], v[152:155], 0
    v_exp_f32 v221, v221
    v_exp_f32 v222, v222
    v_exp_f32 v223, v223
    v_mfma_f32_16x16x32_bf16 v[236:239], v[216:219], v[156:159], 0
    v_mul_f32 v213, v220, v244
    v_fmac_f32 v213, v221, v245
    v_fmac_f32 v213, v222, v246
    v_fmac_f32 v213, v223, v247
    v_mfma_f32_16x16x32_bf16 v[240:243], v[216:219], v[160:163], 0
    v_rcp_f32 v214, v213
    v_log_f32 v213, v213
    v_mfma_f32_16x16x32_bf16 v[244:247], v[216:219], v[164:167], 0
    v_pk_mul_f32 v[220:221], v[220:221], v[214:215] op_sel_hi:[1,0]
    v_pk_mul_f32 v[222:223], v[222:223], v[214:215] op_sel_hi:[1,0]
    v_mfma_f32_16x16x32_bf16 v[248:251], v[216:219], v[168:171], 0
    v_mul_f32 v208, v220, v224
    v_fmac_f32 v208, v221, v229
    v_mfma_f32_16x16x32_bf16 v[252:255], v[216:219], v[172:175], 0
    v_fmac_f32 v208, v222, v234
    v_mfma_f32_16x16x32_bf16 v[224:227], v[216:219], v[176:179], 0
    v_fmac_f32 v208, v223, v239
    v_mfma_f32_16x16x32_bf16 v[228:231], v[216:219], v[180:183], 0
    v_add_f32 v214, v213, v212
    s_mov_b64 exec, s[84:85]
    buffer_store_dword v214, v9, s[56:59], s72 offen sc1
    s_mov_b64 exec, -1
    v_mul_f32 v209, v220, v240
    v_mfma_f32_16x16x32_bf16 v[232:235], v[216:219], v[184:187], 0
    v_fmac_f32 v209, v221, v245
    v_mfma_f32_16x16x32_bf16 v[236:239], v[216:219], v[188:191], 0
    v_fmac_f32 v209, v222, v250
    v_mfma_f32_16x16x32_bf16 v[240:243], v[216:219], v[192:195], 0
    v_fmac_f32 v209, v223, v255
    v_cvt_pk_bf16_f32 v208, v208, v209
    v_mfma_f32_16x16x32_bf16 v[244:247], v[216:219], v[196:199], 0
    v_mul_f32 v210, v220, v224
    v_mfma_f32_16x16x32_bf16 v[248:251], v[216:219], v[200:203], 0
    v_fmac_f32 v210, v221, v229
    v_mfma_f32_16x16x32_bf16 v[252:255], v[216:219], v[204:207], 0
    v_fmac_f32 v210, v222, v234
    v_mfma_f32_16x16x32_bf16 v[224:227], v[216:219], v[16:19], 0
    v_fmac_f32 v210, v223, v239
    v_mfma_f32_16x16x32_bf16 v[228:231], v[216:219], v[20:23], 0
    v_mul_f32 v211, v220, v240
    v_mfma_f32_16x16x32_bf16 v[232:235], v[216:219], v[24:27], 0
    v_fmac_f32 v211, v221, v245
    v_mfma_f32_16x16x32_bf16 v[236:239], v[216:219], v[28:31], 0
    v_fmac_f32 v211, v222, v250
    v_mfma_f32_16x16x32_bf16 v[240:243], v[216:219], v[32:35], 0
    v_fmac_f32 v211, v223, v255
    v_cvt_pk_bf16_f32 v209, v210, v211
    v_mfma_f32_16x16x32_bf16 v[244:247], v[216:219], v[36:39], 0
    v_mul_f32 v212, v220, v224
    v_mfma_f32_16x16x32_bf16 v[248:251], v[216:219], v[40:43], 0
    v_fmac_f32 v212, v221, v229
    v_mfma_f32_16x16x32_bf16 v[252:255], v[216:219], v[44:47], 0
    v_fmac_f32 v212, v222, v234
    v_mfma_f32_16x16x32_bf16 v[224:227], v[216:219], v[48:51], 0
    v_fmac_f32 v212, v223, v239
    v_mfma_f32_16x16x32_bf16 v[228:231], v[216:219], v[52:55], 0
    v_mul_f32 v213, v220, v240
    v_mfma_f32_16x16x32_bf16 v[232:235], v[216:219], v[56:59], 0
    v_fmac_f32 v213, v221, v245
    v_mfma_f32_16x16x32_bf16 v[236:239], v[216:219], v[60:63], 0
    v_fmac_f32 v213, v222, v250
    v_mfma_f32_16x16x32_bf16 v[240:243], v[216:219], v[64:67], 0
    v_fmac_f32 v213, v223, v255
    v_cvt_pk_bf16_f32 v210, v212, v213
    v_mfma_f32_16x16x32_bf16 v[244:247], v[216:219], v[68:71], 0
    v_mul_f32 v214, v220, v224
    v_mfma_f32_16x16x32_bf16 v[248:251], v[216:219], v[72:75], 0
    v_fmac_f32 v214, v221, v229
    v_mfma_f32_16x16x32_bf16 v[252:255], v[216:219], v[76:79], 0
    v_fmac_f32 v214, v222, v234
    v_fmac_f32 v214, v223, v239
    v_mul_f32 v215, v220, v240
    s_nop 0
    v_fmac_f32 v215, v221, v245
    s_nop 0
    v_fmac_f32 v215, v222, v250
    s_nop 0
    v_fmac_f32 v215, v223, v255
    v_cvt_pk_bf16_f32 v211, v214, v215
    buffer_store_dwordx4 v[208:211], v4, s[56:59], s68 offen sc1
    s_cmp_eq_u32 s69, 1
    s_cbranch_scc1 La_ft
La_ft_back:
    s_barrier
    s_cmp_eq_u32 s69, 2
    s_cbranch_scc1 La_exit
    s_mov_b32 s69, 2
    s_mov_b32 s68, 4194304
    s_branch La_loop
La_exit:
Lend:
    s_endpgm
    .p2align 6
Lproj:
    s_lshr_b32 s72, s65, 3
    s_lshl_b32 s73, s64, 2
    s_add_u32 s72, s72, s73
    s_lshl_b32 s83, s72, 8
    s_and_b32 s73, s65, 3
    s_lshl_b32 s73, s73, 6
    s_add_u32 s83, s83, s73
    v_bfe_u32 v188, v0, 2, 2
    v_and_b32 v189, 3, v0
    v_lshlrev_b32 v189, 4, v189
    v_and_b32 v190, 16, v0
    v_lshlrev_b32 v190, 1, v190
    v_xor_b32 v198, v189, v190
    v_mul_u32_u24 v197, 40, v2
    v_add_u32 v191, v197, v188
    v_lshl_add_u32 v191, v191, 13, v198
    s_mul_i32 s74, s67, 1310720
    s_add_u32 s74, s74, s83
    v_lshrrev_b32 v192, 2, v0
    v_lshl_add_u32 v192, v192, 13, v198
    s_mul_i32 s75, s67, 320
    v_lshlrev_b32 v4, 4, v1
    v_lshl_add_u32 v4, v197, 1, v4
    v_add_u32 v4, s75, v4
    v_cmp_gt_u32 vcc, 5, v1
    v_mov_b32 v197, 2147483648
    s_bfe_u32 s76, s65, 0x10002
    v_cndmask_b32 v4, v197, v4, vcc
    s_lshl_b32 s77, s76, 2
    s_add_u32 s77, s77, s67
    s_lshl_b32 s79, s67, 15
    s_add_u32 s79, s79, 16384
    v_lshrrev_b32 v194, 2, v0
    v_lshlrev_b32 v194, 6, v194
    v_lshrrev_b32 v195, 1, v189
    v_add3_u32 v194, v194, v195, v190
    v_and_b32 v197, 4, v1
    v_lshlrev_b32 v197, 3, v197
    v_lshlrev_b32 v198, 4, v2
    v_xor_b32 v197, v197, v198
    v_lshl_add_u32 v196, v1, 6, v197
    v_add_u32 v196, s79, v196
    v_add_u32 v200, s79, v194
    v_xor_b32 v201, 32, v200
    s_mov_b32 m0, s79
    v_lshlrev_b32 v3, 2, v0
    v_and_b32 v211, 12, v3
    v_add_u32 v211, 131072, v211
    v_mov_b32 v8, 131072
    s_lshl_b32 s73, s64, 15
    v_lshl_add_u32 v210, v0, 1, s73
    s_lshr_b32 s73, s65, 4
    v_lshl_add_u32 v210, s73, 14, v210
    s_and_b32 s73, s65, 15
    v_lshl_add_u32 v210, s73, 9, v210
    v_lshl_add_u32 v210, s67, 7, v210
    v_add_u32 v210, 262144, v210
    v_mov_b32 v209, 1
    s_lshl_b32 s73, s67, 2
    s_add_u32 s73, s73, 131072
    v_mov_b32 v9, s73
    v_mov_b32 v7, 32
    v_cmp_eq_u32 vcc, 0, v0
    v_lshl_add_u32 v6, v1, 6, v198
    v_add_u32 v6, 131072, v6
    v_cndmask_b32 v7, v7, 0, vcc
    v_cmp_eq_u32 vcc, 8, v0
    v_lshrrev_b32 v197, 1, v2
    v_lshlrev_b32 v5, 9, v197
    v_cndmask_b32 v7, v7, 4, vcc
    v_lshl_add_u32 v7, s67, 3, v7
    v_add_u32 v7, 131072, v7
    v_and_b32 v197, 31, v0
    v_lshl_add_u32 v5, v197, 1, v5
    s_lshl_b32 s73, s67, 6
    s_add_u32 s73, s73, 131072
    v_add_u32 v5, s73, v5
    v_mov_b32 v168, 0x3f803f80
    v_mov_b32 v169, 0x3f803f80
    v_mov_b32 v170, 0x3f803f80
    v_mov_b32 v171, 0x3f803f80
    v_mov_b32 v172, 0x3f803f80
    v_mov_b32 v173, 0x3f803f80
    v_mov_b32 v174, 0x3f803f80
    v_mov_b32 v175, 0x3f803f80
    v_mov_b32 v176, 0x3f803f80
    v_mov_b32 v177, 0x3f803f80
    v_mov_b32 v178, 0x3f803f80
    v_mov_b32 v179, 0x3f803f80
    v_mov_b32 v180, 0x3f803f80
    v_mov_b32 v181, 0x3f803f80
    v_mov_b32 v182, 0x3f803f80
    v_mov_b32 v183, 0x3f803f80
    v_mov_b32 v184, 0x3f803f80
    v_mov_b32 v185, 0x3f803f80
    v_mov_b32 v186, 0x3f803f80
    v_mov_b32 v187, 0x3f803f80
    s_waitcnt lgkmcnt(0)
    s_mov_b32 s60, s4
    s_mov_b32 s61, s5
    s_mov_b32 s62, 1280
    s_mov_b32 s63, 0x20000
    s_barrier
    buffer_load_dwordx4 v[248:251], v4, s[60:63], 0 offen
    buffer_load_dwordx4 v191, s[32:35], s74 offen  lds
    s_add_u32 m0, m0, 1024
    s_add_u32 s74, s74, 32768
    buffer_load_dwordx4 v191, s[32:35], s74 offen  lds
    s_add_u32 m0, m0, 1024
    s_add_u32 s74, s74, 32768
    buffer_load_dwordx4 v191, s[32:35], s74 offen  lds
    s_add_u32 m0, m0, 1024
    s_add_u32 s74, s74, 32768
    buffer_load_dwordx4 v191, s[32:35], s74 offen  lds
    s_add_u32 m0, m0, 1024
    s_add_u32 s74, s74, 32768
    buffer_load_dwordx4 v191, s[32:35], s74 offen  lds
    s_add_u32 m0, m0, 1024
    s_add_u32 s74, s74, 32768
    buffer_load_dwordx4 v191, s[32:35], s74 offen  lds
    s_add_u32 m0, m0, 1024
    s_add_u32 s74, s74, 32768
    buffer_load_dwordx4 v191, s[32:35], s74 offen  lds
    s_add_u32 m0, m0, 1024
    s_add_u32 s74, s74, 32768
    buffer_load_dwordx4 v191, s[32:35], s74 offen  lds
    s_add_u32 m0, m0, 1024
    s_add_u32 s74, s74, 32768
    buffer_load_dwordx4 v191, s[32:35], s74 offen  lds
    s_add_u32 m0, m0, 1024
    s_add_u32 s74, s74, 32768
    buffer_load_dwordx4 v191, s[32:35], s74 offen  lds
    s_add_u32 m0, m0, 1024
    s_lshl_b32 s74, s77, 19
    s_add_u32 s74, s74, s83
    buffer_load_dwordx4 v192, s[36:39], s74 offen  lds
    s_add_u32 m0, m0, 1024
    s_add_u32 s74, s74, 131072
    buffer_load_dwordx4 v192, s[36:39], s74 offen  lds
    s_add_u32 m0, m0, 1024
    s_add_u32 s74, s74, 131072
    buffer_load_dwordx4 v192, s[36:39], s74 offen  lds
    s_add_u32 m0, m0, 1024
    s_add_u32 s74, s74, 131072
    buffer_load_dwordx4 v192, s[36:39], s74 offen  lds
    ds_write_b32 v9, v209 offset:27360
    s_mov_b32 s84, 0xffff0000
    s_mov_b32 s85, 0xffff0000
    s_mov_b32 s86, 0
    s_mov_b32 s87, -1
    ds_read_b32 v228, v8 offset:27408
    s_waitcnt vmcnt(12)
    ds_read_b64_tr_b16 v[16:17], v200 offset:0
    ds_read_b64_tr_b16 v[18:19], v200 offset:1024
    ds_read_b64_tr_b16 v[20:21], v201 offset:0
    ds_read_b64_tr_b16 v[22:23], v201 offset:1024
    s_waitcnt vmcnt(10)
    ds_read_b64_tr_b16 v[24:25], v200 offset:2048
    ds_read_b64_tr_b16 v[26:27], v200 offset:3072
    ds_read_b64_tr_b16 v[28:29], v201 offset:2048
    ds_read_b64_tr_b16 v[30:31], v201 offset:3072
    s_waitcnt vmcnt(8)
    ds_read_b64_tr_b16 v[32:33], v200 offset:4096
    ds_read_b64_tr_b16 v[34:35], v200 offset:5120
    ds_read_b64_tr_b16 v[36:37], v201 offset:4096
    ds_read_b64_tr_b16 v[38:39], v201 offset:5120
    s_waitcnt vmcnt(6)
    ds_read_b64_tr_b16 v[40:41], v200 offset:6144
    ds_read_b64_tr_b16 v[42:43], v200 offset:7168
    ds_read_b64_tr_b16 v[44:45], v201 offset:6144
    ds_read_b64_tr_b16 v[46:47], v201 offset:7168
    s_waitcnt vmcnt(4)
    ds_read_b64_tr_b16 v[48:49], v200 offset:8192
    ds_read_b64_tr_b16 v[50:51], v200 offset:9216
    ds_read_b64_tr_b16 v[52:53], v201 offset:8192
    ds_read_b64_tr_b16 v[54:55], v201 offset:9216
    s_waitcnt vmcnt(2)
    ds_read_b128 v[56:59], v196 offset:10240
    ds_read_b128 v[60:63], v196 offset:11264
    s_waitcnt vmcnt(0)
    ds_read_b128 v[64:67], v196 offset:12288
    ds_read_b128 v[68:71], v196 offset:13312
    s_waitcnt lgkmcnt(4)
    v_cmp_eq_u32 vcc, 0, v228
    s_cbranch_vccnz Lg_fcwait
    s_branch Lg_s1
    .p2align 6
Lg_again:
    s_add_u32 s72, s23, 10240
    buffer_load_dwordx4 v[248:251], v4, s[56:59], s72 offen sc1
    v_mov_b32 v209, 2
    s_mov_b32 s69, 2
    s_mov_b32 s68, 4194304
    s_lshl_b32 s36, s67, 7
    s_add_u32 s36, s36, 158592
    s_add_u32 s33, s68, 64512
    s_add_u32 s34, s68, 129024
    s_add_u32 s35, s68, 193536
    s_lshl_b32 s21, s69, 1
    s_sub_u32 s21, s21, 2
    s_mul_i32 s23, s64, 1280
    s_add_u32 s23, s23, s68
    s_add_u32 s23, s23, 81920
Lxp18:
    buffer_load_dwordx4 v[248:251], v4, s[56:59], s72 offen sc1
    s_add_u32 s70, s70, 1
    s_cmp_ge_u32 s70, 4194304
    s_cbranch_scc1 Lok19
    s_waitcnt vmcnt(1)
    v_cmp_eq_u32 vcc, -1, v248
    s_cbranch_vccnz Lxp18
Lok19:
Lg_s1:
    v_mov_b32_dpp v168, v248 row_newbcast:0 row_mask:0xf bank_mask:0x3
    v_mov_b32_dpp v169, v249 row_newbcast:0 row_mask:0xf bank_mask:0x3
    v_mov_b32_dpp v170, v250 row_newbcast:0 row_mask:0xf bank_mask:0x3
    v_mov_b32_dpp v171, v251 row_newbcast:0 row_mask:0xf bank_mask:0x3
    v_mov_b32_dpp v172, v248 row_newbcast:1 row_mask:0xf bank_mask:0x3
    v_mov_b32_dpp v173, v249 row_newbcast:1 row_mask:0xf bank_mask:0x3
    v_mfma_f32_16x16x32_bf16 v[216:219], v[168:171], v[16:19], 0
    v_mov_b32_dpp v174, v250 row_newbcast:1 row_mask:0xf bank_mask:0x3
    v_mov_b32_dpp v175, v251 row_newbcast:1 row_mask:0xf bank_mask:0x3
    v_mfma_f32_16x16x32_bf16 v[220:223], v[168:171], v[20:23], 0
    v_mov_b32_dpp v176, v248 row_newbcast:2 row_mask:0xf bank_mask:0x3
    v_mov_b32_dpp v177, v249 row_newbcast:2 row_mask:0xf bank_mask:0x3
    v_mfma_f32_16x16x32_bf16 v[216:219], v[172:175], v[24:27], v[216:219]
    v_mov_b32_dpp v178, v250 row_newbcast:2 row_mask:0xf bank_mask:0x3
    v_mov_b32_dpp v179, v251 row_newbcast:2 row_mask:0xf bank_mask:0x3
    v_mfma_f32_16x16x32_bf16 v[220:223], v[172:175], v[28:31], v[220:223]
    v_mov_b32_dpp v180, v248 row_newbcast:3 row_mask:0xf bank_mask:0x3
    v_mov_b32_dpp v181, v249 row_newbcast:3 row_mask:0xf bank_mask:0x3
    v_mfma_f32_16x16x32_bf16 v[216:219], v[176:179], v[32:35], v[216:219]
    v_mov_b32_dpp v182, v250 row_newbcast:3 row_mask:0xf bank_mask:0x3
    v_mov_b32_dpp v183, v251 row_newbcast:3 row_mask:0xf bank_mask:0x3
    v_mfma_f32_16x16x32_bf16 v[220:223], v[176:179], v[36:39], v[220:223]
    v_mov_b32_dpp v184, v248 row_newbcast:4 row_mask:0xf bank_mask:0x3
    v_mov_b32_dpp v185, v249 row_newbcast:4 row_mask:0xf bank_mask:0x3
    v_mfma_f32_16x16x32_bf16 v[216:219], v[180:183], v[40:43], v[216:219]
    v_mov_b32_dpp v186, v250 row_newbcast:4 row_mask:0xf bank_mask:0x3
    v_mov_b32_dpp v187, v251 row_newbcast:4 row_mask:0xf bank_mask:0x3
    v_mfma_f32_16x16x32_bf16 v[220:223], v[180:183], v[44:47], v[220:223]
    v_mov_b32 v252, 0x3727c5ac
    v_mfma_f32_16x16x32_bf16 v[216:219], v[184:187], v[48:51], v[216:219]
    v_mfma_f32_16x16x32_bf16 v[220:223], v[184:187], v[52:55], v[220:223]
    v_xor_b32 v254, 0x2000, v210
    v_mfma_f32_16x16x32_bf16 v[224:227], v[168:171], v[168:171], 0
    v_mfma_f32_16x16x32_bf16 v[224:227], v[172:175], v[172:175], v[224:227]
    v_mfma_f32_16x16x32_bf16 v[224:227], v[176:179], v[176:179], v[224:227]
    v_mfma_f32_16x16x32_bf16 v[224:227], v[180:183], v[180:183], v[224:227]
    v_mfma_f32_16x16x32_bf16 v[224:227], v[184:187], v[184:187], v[224:227]
    s_nop 1
    v_cndmask_b32 v228, v216, v220, s[84:85]
    v_and_b32 v229, 0xffff0000, v228
    ds_write_b16_d16_hi v5, v228 offset:24576
    v_sub_f32 v229, v228, v229
    ds_write_b16_d16_hi v5, v229 offset:24832
    s_nop 0
    ds_write_b32 v7, v224 offset:27136
    ds_write_b32 v9, v209 offset:27264
Lf13:
    ds_read_b32 v244, v211 offset:27264
    ds_read_b128 v[232:235], v6 offset:24576
    ds_read_b128 v[236:239], v8 offset:27136
    ds_read_b128 v[240:243], v8 offset:27152
    s_add_u32 s70, s70, 1
    s_cmp_ge_u32 s70, 4194304
    s_cbranch_scc1 Lok4
    s_waitcnt lgkmcnt(3)
    v_cmp_gt_u32 vcc, s69, v244
    s_cbranch_vccnz Lf13
Lok4:
    s_waitcnt lgkmcnt(2)
    v_mfma_f32_16x16x32_bf16 v[216:219], v[232:235], v[56:59], 0
    v_mfma_f32_16x16x32_bf16 v[220:223], v[232:235], v[60:63], 0
    v_mfma_f32_16x16x32_bf16 v[224:227], v[232:235], v[64:67], 0
    v_mfma_f32_16x16x32_bf16 v[228:231], v[232:235], v[68:71], 0
    s_waitcnt lgkmcnt(0)
    v_pk_add_f32 v[236:237], v[236:237], v[238:239]
    v_pk_add_f32 v[240:241], v[240:241], v[242:243]
    v_pk_add_f32 v[236:237], v[236:237], v[240:241]
    v_mul_f32 v237, 0x3acccccd, v237
    v_fmamk_f32 v236, v236, 0x3acccccd, v252
    v_fma_f32 v236, -v237, v237, v236
    v_max_f32 v236, v252, v236
    v_rsq_f32 v236, v236
    v_cndmask_b32 v240, 1.0, -v237, s[86:87]
    v_pk_add_f32 v[216:217], v[216:217], v[218:219]
    v_pk_add_f32 v[220:221], v[220:221], v[222:223]
    v_pk_add_f32 v[224:225], v[224:225], v[226:227]
    v_pk_add_f32 v[228:229], v[228:229], v[230:231]
    v_mul_f32 v236, v236, v240
    v_add_f32 v216, v216, v217
    v_add_f32 v220, v220, v221
    v_add_f32 v224, v224, v225
    v_add_f32 v228, v228, v229
    v_mul_f32 v216, v216, v236
    v_mul_f32 v224, v224, v236
    v_mul_f32 v220, v220, v236
    v_mul_f32 v228, v228, v236
    v_permlane32_swap_b32 v216, v224
    s_nop 0
    v_permlane32_swap_b32 v220, v228
    v_add_f32 v216, v216, v224
    v_add_f32 v220, v220, v228
    s_nop 1
    v_permlane16_swap_b32 v216, v220
    v_add_f32 v216, v216, v220
    s_nop 1
    v_mov_b32_dpp v217, v216 row_shl:1 row_mask:0xf bank_mask:0xf
    v_cvt_pk_bf16_f32 v232, v216, v217
    s_nop 1
    v_mov_b32_dpp v233, v232 row_shl:2 row_mask:0xf bank_mask:0xf
    v_mov_b32_dpp v234, v232 row_shl:4 row_mask:0xf bank_mask:0xf
    v_mov_b32_dpp v235, v232 row_shl:6 row_mask:0xf bank_mask:0xf
    s_mov_b32 exec_lo, 0x01010101
    s_mov_b32 exec_hi, 0x01010101
    buffer_store_dwordx4 v[232:235], v254, s[56:59], s68 offen sc1
    buffer_store_dwordx4 v[232:235], v210, s[56:59], s68 offen sc1
    s_mov_b64 exec, -1
    s_cmp_eq_u32 s69, 1
    s_cbranch_scc1 Lg_bulk2
    s_barrier
    s_cmp_ge_u32 s90, 40
    s_cbranch_scc1 Lg_b2
Llw5:
    ds_read_b128 v[216:219], v8 offset:27344
    s_add_u32 s70, s70, 1
    s_cmp_ge_u32 s70, 4194304
    s_cbranch_scc1 Lok6
    s_waitcnt lgkmcnt(0)
    v_min3_u32 v216, v216, v217, v218
    v_min_u32 v216, v216, v219
    v_cmp_gt_u32 vcc, s69, v216
    s_cbranch_vccnz Llw5
Lok6:
    v_mul_u32_u24 v220, 2688, v0
    v_mul_u32_u24 v221, 10240, v0
    s_min_u32 s37, s90, 39
    s_lshl_b32 s37, s37, 5
    s_add_u32 s37, s37, s23
    s_cmp_lt_u32 s90, 40
    s_cselect_b32 exec_lo, -1, 1
    s_mov_b32 exec_hi, 0
    buffer_load_dword v222, v220, s[56:59], s22 offen sc1
    s_mov_b64 exec, 3
    buffer_load_dword v222, v221, s[56:59], s37 offen sc1
    s_mov_b64 exec, -1
Lg_b2:
    s_barrier
    s_sleep 9
Lg_b2x:
Lg_h2:
    s_mov_b32 m0, s36
    s_mov_b32 exec_hi, 0
    buffer_load_dword v208, s[56:59], s68 offen sc1 lds
    s_mov_b32 exec_hi, -1
    s_mov_b32 m0, s95
    s_nop 0
    buffer_load_dwordx4 v10, s[56:59], s68 offen offset:0 sc1 lds
    buffer_load_dwordx4 v205, s[56:59], s33 offen offset:1024 sc1 lds
    buffer_load_dwordx4 v10, s[56:59], s34 offen offset:2048 sc1 lds
    buffer_load_dwordx4 v205, s[56:59], s35 offen offset:3072 sc1 lds
    s_cmp_lg_u32 s20, 0
    s_cbranch_scc1 Lg_rest
Lg_rest_back:
    s_add_u32 s70, s70, 1
    s_cmp_ge_u32 s70, 4194304
    s_cbranch_scc1 Lok7
    s_waitcnt vmcnt(4)
    ds_read_b128 v[232:235], v204
    ds_read_b128 v[236:239], v204 offset:64
    s_waitcnt vmcnt(2)
    ds_read_b128 v[216:219], v206
    ds_read_b128 v[220:223], v207
    s_waitcnt vmcnt(0)
    ds_read_b128 v[224:227], v206 offset:2048
    ds_read_b128 v[228:231], v207 offset:2048
    s_waitcnt lgkmcnt(4)
    v_max3_f32 v212, v232, v233, v234
    v_max3_f32 v212, v212, v235, v236
    v_max3_f32 v212, v212, v237, v238
    v_max_f32 v212, v212, v239
    v_max3_u32 v214, v232, v233, v234
    v_max3_u32 v214, v214, v235, v236
    v_max3_u32 v214, v214, v237, v238
    v_max_u32 v214, v214, v239
    v_mov_b32 v213, v212
    s_waitcnt lgkmcnt(2)
    v_mfma_f32_16x16x32_bf16 v[240:243], v[216:219], v[72:75], 0
    v_mfma_f32_16x16x32_bf16 v[244:247], v[216:219], v[76:79], 0
    v_permlane32_swap_b32 v212, v213
    v_max_f32 v212, v212, v213
    v_mfma_f32_16x16x32_bf16 v[240:243], v[220:223], v[80:83], v[240:243]
    v_mov_b32 v213, v212
    v_max3_u32 v214, v214, v216, v220
    v_mfma_f32_16x16x32_bf16 v[244:247], v[220:223], v[84:87], v[244:247]
    s_waitcnt lgkmcnt(0)
    v_mfma_f32_16x16x32_bf16 v[248:251], v[224:227], v[72:75], 0
    v_permlane16_swap_b32 v212, v213
    v_max3_u32 v214, v214, v224, v228
    v_mfma_f32_16x16x32_bf16 v[252:255], v[224:227], v[76:79], 0
    v_max_f32 v212, v212, v213
    v_cmp_eq_u32 vcc, -1, v214
    v_mfma_f32_16x16x32_bf16 v[248:251], v[228:231], v[80:83], v[248:251]
    s_cbranch_vccnz Lg_h2
Lok7:
    v_mfma_f32_16x16x32_bf16 v[252:255], v[228:231], v[84:87], v[252:255]
    v_pk_add_f32 v[232:233], v[232:233], v[212:213] op_sel_hi:[1,0] neg_lo:[0,1] neg_hi:[0,1]
    v_pk_add_f32 v[234:235], v[234:235], v[212:213] op_sel_hi:[1,0] neg_lo:[0,1] neg_hi:[0,1]
    v_pk_add_f32 v[236:237], v[236:237], v[212:213] op_sel_hi:[1,0] neg_lo:[0,1] neg_hi:[0,1]
    v_pk_add_f32 v[238:239], v[238:239], v[212:213] op_sel_hi:[1,0] neg_lo:[0,1] neg_hi:[0,1]
    v_exp_f32 v232, v232
    v_exp_f32 v233, v233
    v_exp_f32 v234, v234
    v_exp_f32 v235, v235
    v_pk_mul_f32 v[218:219], v[232:233], v[240:241]
    v_pk_mul_f32 v[220:221], v[232:233], v[244:245]
    v_exp_f32 v236, v236
    v_exp_f32 v237, v237
    v_pk_fma_f32 v[218:219], v[234:235], v[242:243], v[218:219]
    v_pk_fma_f32 v[220:221], v[234:235], v[246:247], v[220:221]
    v_exp_f32 v238, v238
    v_exp_f32 v239, v239
    v_pk_fma_f32 v[218:219], v[236:237], v[248:249], v[218:219]
    v_pk_fma_f32 v[220:221], v[236:237], v[252:253], v[220:221]
    v_pk_fma_f32 v[218:219], v[238:239], v[250:251], v[218:219]
    v_pk_fma_f32 v[220:221], v[238:239], v[254:255], v[220:221]
    v_add_f32 v218, v218, v219
    v_add_f32 v220, v220, v221
    v_pk_add_f32 v[232:233], v[232:233], v[234:235]
    v_pk_add_f32 v[236:237], v[236:237], v[238:239]
    v_permlane16_swap_b32 v218, v220
    v_add_f32 v218, v218, v220
    v_mov_b32 v220, v218
    v_pk_add_f32 v[232:233], v[232:233], v[236:237]
    v_add_f32 v232, v232, v233
    v_permlane32_swap_b32 v218, v220
    v_add_f32 v218, v218, v220
    v_cvt_pk_bf16_f32 v218, v218, v218
    ds_write_b16 v5, v218 offset:25600
    ds_write_b32 v9, v209 offset:27296
Lf38:
    ds_read_b32 v224, v211 offset:27296
    s_mov_b64 exec, s[38:39]
    ds_read_b128 v[188:191], v6 offset:25600
    s_lshl_b64 exec, exec, 4
    ds_read_b128 v[192:195], v6 offset:25344
    s_lshl_b64 exec, exec, 4
    ds_read_b128 v[196:199], v6 offset:25088
    s_lshl_b64 exec, exec, 4
    ds_read_b128 v[200:203], v6 offset:24832
    s_mov_b64 exec, -1
    s_add_u32 s70, s70, 1
    s_cmp_ge_u32 s70, 4194304
    s_cbranch_scc1 Lok9
    s_waitcnt lgkmcnt(4)
    v_cmp_gt_u32 vcc, s69, v224
    s_cbranch_vccnz Lf38
Lok9:
    s_waitcnt lgkmcnt(3)
    v_mfma_f32_16x16x32_bf16 v[240:243], v[188:191], v[88:91], 0
    v_mov_b32 v233, v232
    s_waitcnt lgkmcnt(2)
    v_mfma_f32_16x16x32_bf16 v[240:243], v[192:195], v[92:95], v[240:243]
    s_waitcnt lgkmcnt(1)
    v_mfma_f32_16x16x32_bf16 v[240:243], v[196:199], v[96:99], v[240:243]
    v_permlane32_swap_b32 v232, v233
    v_add_f32 v232, v232, v233
    s_waitcnt lgkmcnt(0)
    v_mfma_f32_16x16x32_bf16 v[240:243], v[200:203], v[100:103], v[240:243]
    v_mov_b32 v233, v232
    v_mfma_f32_16x16x32_bf16 v[244:247], v[188:191], v[104:107], 0
    v_mfma_f32_16x16x32_bf16 v[244:247], v[192:195], v[108:111], v[244:247]
    v_permlane16_swap_b32 v232, v233
    v_add_f32 v232, v232, v233
    v_mfma_f32_16x16x32_bf16 v[244:247], v[196:199], v[112:115], v[244:247]
    v_rcp_f32 v232, v232
    v_mfma_f32_16x16x32_bf16 v[244:247], v[200:203], v[116:119], v[244:247]
    v_mfma_f32_16x16x32_bf16 v[248:251], v[188:191], v[120:123], 0
    v_mfma_f32_16x16x32_bf16 v[248:251], v[192:195], v[124:127], v[248:251]
    s_cmp_lg_u32 s71, 0
    s_cbranch_scc1 Lms10
    v_pk_add_f32 v[240:241], v[240:241], v[242:243]
    v_add_f32 v240, v240, v241
    v_mul_f32 v240, v240, v232
    v_and_or_b32 v240, v240, -4, s21
    buffer_store_dword v240, v3, s[56:59], s3 offen offset:0
    v_pk_add_f32 v[244:245], v[244:245], v[246:247]
    v_add_f32 v244, v244, v245
    v_mul_f32 v244, v244, v232
    v_and_or_b32 v244, v244, -4, s21
    buffer_store_dword v244, v3, s[56:59], s3 offen offset:256
    v_pk_add_f32 v[248:249], v[248:249], v[250:251]
    v_add_f32 v248, v248, v249
    v_mul_f32 v248, v248, v232
    v_and_or_b32 v248, v248, -4, s21
    s_mov_b32 exec_hi, 0
    buffer_store_dword v248, v3, s[56:59], s3 offen offset:512
    s_mov_b32 exec_hi, -1
Lmd11:
    s_cmp_eq_u32 s81, 0
    s_cbranch_scc1 Lg_reduce
    s_cmp_eq_u32 s69, 1
    s_cbranch_scc1 Lg_ffnre
Lg_ffnre_back:
    buffer_load_dwordx4 v[248:251], v4, s[56:59], s23 offen sc1
    v_mov_b32 v216, 0
    v_mov_b32 v217, 0
    v_mov_b32 v218, 0
    v_mov_b32 v219, 0
    v_mov_b32 v220, 0
    v_mov_b32 v221, 0
    v_mov_b32 v222, 0
    v_mov_b32 v223, 0
    s_add_u32 s21, s21, 1
    v_mov_b32 v252, 0x3727c5ac
    v_mov_b32 v253, 0xc0135761
    s_sleep 1
Lxp12:
    buffer_load_dwordx4 v[248:251], v4, s[56:59], s23 offen sc1
    s_add_u32 s70, s70, 1
    s_cmp_ge_u32 s70, 4194304
    s_cbranch_scc1 Lok13
    s_waitcnt vmcnt(1)
    v_cmp_eq_u32 vcc, -1, v248
    s_cbranch_vccnz Lxp12
Lok13:
    v_mov_b32_dpp v168, v248 row_newbcast:0 row_mask:0xf bank_mask:0x3
    v_mov_b32_dpp v169, v249 row_newbcast:0 row_mask:0xf bank_mask:0x3
    v_mov_b32_dpp v170, v250 row_newbcast:0 row_mask:0xf bank_mask:0x3
    v_mov_b32_dpp v171, v251 row_newbcast:0 row_mask:0xf bank_mask:0x3
    v_mov_b32_dpp v172, v248 row_newbcast:1 row_mask:0xf bank_mask:0x3
    v_mov_b32_dpp v173, v249 row_newbcast:1 row_mask:0xf bank_mask:0x3
    v_mfma_f32_16x16x32_bf16 v[224:227], v[168:171], v[168:171], 0
    v_mov_b32_dpp v174, v250 row_newbcast:1 row_mask:0xf bank_mask:0x3
    v_mov_b32_dpp v175, v251 row_newbcast:1 row_mask:0xf bank_mask:0x3
    v_mfma_f32_16x16x32_bf16 v[228:231], v[168:171], v[128:131], 0
    v_mov_b32_dpp v176, v248 row_newbcast:2 row_mask:0xf bank_mask:0x3
    v_mov_b32_dpp v177, v249 row_newbcast:2 row_mask:0xf bank_mask:0x3
    v_mfma_f32_16x16x32_bf16 v[224:227], v[172:175], v[172:175], v[224:227]
    v_mov_b32_dpp v178, v250 row_newbcast:2 row_mask:0xf bank_mask:0x3
    v_mov_b32_dpp v179, v251 row_newbcast:2 row_mask:0xf bank_mask:0x3
    v_mfma_f32_16x16x32_bf16 v[228:231], v[172:175], v[132:135], v[228:231]
    v_mov_b32_dpp v180, v248 row_newbcast:3 row_mask:0xf bank_mask:0x3
    v_mov_b32_dpp v181, v249 row_newbcast:3 row_mask:0xf bank_mask:0x3
    v_mfma_f32_16x16x32_bf16 v[224:227], v[176:179], v[176:179], v[224:227]
    v_mov_b32_dpp v182, v250 row_newbcast:3 row_mask:0xf bank_mask:0x3
    v_mov_b32_dpp v183, v251 row_newbcast:3 row_mask:0xf bank_mask:0x3
    v_mfma_f32_16x16x32_bf16 v[228:231], v[176:179], v[136:139], v[228:231]
    v_mov_b32_dpp v184, v248 row_newbcast:4 row_mask:0xf bank_mask:0x3
    v_mov_b32_dpp v185, v249 row_newbcast:4 row_mask:0xf bank_mask:0x3
    v_mfma_f32_16x16x32_bf16 v[224:227], v[180:183], v[180:183], v[224:227]
    v_mov_b32_dpp v186, v250 row_newbcast:4 row_mask:0xf bank_mask:0x3
    v_mov_b32_dpp v187, v251 row_newbcast:4 row_mask:0xf bank_mask:0x3
    v_mfma_f32_16x16x32_bf16 v[228:231], v[180:183], v[140:143], v[228:231]
    s_nop 0
    v_mfma_f32_16x16x32_bf16 v[224:227], v[184:187], v[184:187], v[224:227]
    v_mfma_f32_16x16x32_bf16 v[228:231], v[184:187], v[144:147], v[228:231]
    s_nop 6
    ds_write_b32 v7, v224 offset:27200
    ds_write_b32 v12, v228 offset:26624
    ds_write_b32 v9, v209 offset:27312
Lf414:
    ds_read_b32 v244, v211 offset:27312
    ds_read_b128 v[236:239], v8 offset:27200
    ds_read_b128 v[240:243], v8 offset:27216
    ds_read_b128 v[228:231], v13 offset:26624
    ds_read_b128 v[232:235], v13 offset:26640
    s_add_u32 s70, s70, 1
    s_cmp_ge_u32 s70, 4194304
    s_cbranch_scc1 Lok15
    s_waitcnt lgkmcnt(4)
    v_cmp_gt_u32 vcc, s69, v244
    s_cbranch_vccnz Lf414
Lok15:
    s_waitcnt lgkmcnt(2)
    v_pk_add_f32 v[236:237], v[236:237], v[238:239]
    v_pk_add_f32 v[240:241], v[240:241], v[242:243]
    v_pk_add_f32 v[236:237], v[236:237], v[240:241]
    v_mul_f32 v237, 0x3acccccd, v237
    v_fmamk_f32 v236, v236, 0x3acccccd, v252
    v_fma_f32 v236, -v237, v237, v236
    v_max_f32 v236, v252, v236
    v_rsq_f32 v236, v236
    s_waitcnt lgkmcnt(0) vmcnt(0)
    v_pk_add_f32 v[228:229], v[228:229], v[230:231]
    v_pk_add_f32 v[232:233], v[232:233], v[234:235]
    v_pk_add_f32 v[228:229], v[228:229], v[232:233]
    v_fma_f32 v228, -v237, v229, v228
    v_fma_f32 v228, v228, v236, v14
    v_mul_f32 v229, v228, v228
    v_fmamk_f32 v230, v229, 0xbdd2d3e8, v253
    v_mul_f32 v230, v230, v228
    v_exp_f32 v230, v230
    s_nop 0
    v_add_f32 v230, 1.0, v230
    v_rcp_f32 v230, v230
    s_nop 0
    v_mul_f32 v228, v228, v230
    s_nop 1
    v_mov_b32_dpp v229, v228 quad_perm:[1,1,3,3] row_mask:0xf bank_mask:0xf
    v_cvt_pk_bf16_f32 v228, v228, v229
    s_nop 1
    v_mov_b32_dpp v216, v228 quad_perm:[0,0,0,0] row_mask:0xf bank_mask:0x1
    v_mov_b32_dpp v217, v228 quad_perm:[2,2,2,2] row_mask:0xf bank_mask:0x1
    v_mov_b32_dpp v218, v228 quad_perm:[0,0,0,0] row_mask:0xf bank_mask:0x2
    v_mov_b32_dpp v219, v228 quad_perm:[2,2,2,2] row_mask:0xf bank_mask:0x2
    v_mov_b32_dpp v220, v228 quad_perm:[0,0,0,0] row_mask:0xf bank_mask:0x4
    v_mov_b32_dpp v221, v228 quad_perm:[2,2,2,2] row_mask:0xf bank_mask:0x4
    v_mfma_f32_16x16x32_bf16 v[248:251], v[216:219], v[164:167], 0
    v_mov_b32_dpp v222, v228 quad_perm:[0,0,0,0] row_mask:0xf bank_mask:0x8
    v_mov_b32_dpp v223, v228 quad_perm:[2,2,2,2] row_mask:0xf bank_mask:0x8
    v_mfma_f32_16x16x32_bf16 v[240:243], v[216:219], v[148:151], 0
    v_mfma_f32_16x16x32_bf16 v[244:247], v[216:219], v[156:159], 0
    v_mfma_f32_16x16x32_bf16 v[240:243], v[220:223], v[152:155], v[240:243]
    v_mfma_f32_16x16x32_bf16 v[244:247], v[220:223], v[160:163], v[244:247]
    s_cmp_lg_u32 s71, 0
    s_cbranch_scc1 Lms16
    v_and_or_b32 v248, v248, -4, s21
    s_mov_b32 exec_hi, 0
    buffer_store_dword v248, v3, s[56:59], s3 offen offset:512
    s_mov_b32 exec_hi, -1
    s_nop 0
    v_and_or_b32 v240, v240, -4, s21
    buffer_store_dword v240, v3, s[56:59], s3 offen offset:0
    v_and_or_b32 v244, v244, -4, s21
    buffer_store_dword v244, v3, s[56:59], s3 offen offset:256
Lmd17:
Lg_next:
    s_cmp_eq_u32 s69, 2
    s_cbranch_scc1 Lg_exit
    s_branch Lg_again
Lg_reduce:
    s_cmp_ge_u32 s90, 40
    s_cbranch_scc1 Lg_next
    s_add_u32 s77, s22, 21504
    s_add_u32 s78, s22, 43008
    s_add_u32 s79, s22, 64512
    buffer_load_dwordx2 v[216:217], v11, s[56:59], s22 offen sc1
    buffer_load_dwordx2 v[218:219], v11, s[56:59], s77 offen sc1
    buffer_load_dwordx2 v[220:221], v11, s[56:59], s78 offen sc1
    buffer_load_dwordx2 v[222:223], v11, s[56:59], s79 offen sc1
    s_lshr_b32 s76, s21, 1
    s_lshl_b32 s74, s90, 5
    s_add_u32 s75, s74, s23
Lrd20:
    buffer_load_dwordx2 v[216:217], v11, s[56:59], s22 offen sc1
    buffer_load_dwordx2 v[218:219], v11, s[56:59], s77 offen sc1
    buffer_load_dwordx2 v[220:221], v11, s[56:59], s78 offen sc1
    buffer_load_dwordx2 v[222:223], v11, s[56:59], s79 offen sc1
    s_add_u32 s70, s70, 1
    s_cmp_ge_u32 s70, 4194304
    s_cbranch_scc1 Lok21
    s_waitcnt vmcnt(4)
    v_bitop3_b32 v224, v216, v217, s21 bitop3:0x7e
    v_bitop3_b32 v225, v218, v219, s21 bitop3:0x7e
    v_bitop3_b32 v226, v220, v221, s21 bitop3:0x7e
    v_bitop3_b32 v227, v222, v223, s21 bitop3:0x7e
    v_or3_b32 v224, v224, v226, v227
    v_bitop3_b32 v224, v224, v225, 3 bitop3:0xa8
    v_cmp_ne_u32 vcc, 0, v224
    s_cbranch_vccnz Lrd20
Lok21:
    v_pk_add_f32 v[228:229], v[216:217], v[218:219]
    v_pk_add_f32 v[230:231], v[220:221], v[222:223]
    v_pk_add_f32 v[228:229], v[228:229], v[230:231]
    v_mov_b32 v237, 0
    v_mov_b32 v236, 0
    v_permlane32_swap_b32 v228, v229
    v_add_f32 v228, v228, v229
    v_mov_b32 v235, 0
    v_mov_b32 v234, 0
    v_add_f32_dpp v228, v228, v228 row_ror:8 row_mask:0xf bank_mask:0xf
    v_mov_b32 v229, v228
    v_mov_b32 v233, 0
    v_mov_b32 v232, 0
    v_permlane16_swap_b32 v228, v229
    v_add_f32 v228, v228, v229
    v_and_or_b32 v228, v228, -2, s76
    v_mov_b32 v229, v228
    s_nop 1
    v_permlane32_swap_b32 v228, v229
    s_mov_b64 exec, s[4:5]
    buffer_store_dwordx2 v[228:229], v157, s[56:59], 0 offen offset:0 sc1
    buffer_atomic_or_x2 v[232:233], v156, s[56:59], 0 offen offset:0 sc0 sc1
    s_sleep 4
    buffer_atomic_or_x2 v[234:235], v156, s[56:59], 0 offen offset:0 sc0 sc1
    s_sleep 4
Lr222:
    buffer_atomic_or_x2 v[236:237], v156, s[56:59], 0 offen offset:0 sc0 sc1
    s_add_u32 s70, s70, 1
    s_cmp_ge_u32 s70, 4194304
    s_cbranch_scc1 Lr2d23
    s_waitcnt vmcnt(2)
    v_and_b32 v224, 1, v232
    v_mov_b32 v228, v232
    v_mov_b32 v229, v233
    v_cmpx_ne_u32 vcc, s76, v224
    s_cbranch_execz Lr2d23
    v_mov_b32 v232, 0
    v_mov_b32 v233, 0
    buffer_atomic_or_x2 v[232:233], v156, s[56:59], 0 offen offset:0 sc0 sc1
    s_waitcnt vmcnt(2)
    v_and_b32 v224, 1, v234
    v_mov_b32 v228, v234
    v_mov_b32 v229, v235
    v_cmpx_ne_u32 vcc, s76, v224
    s_cbranch_execz Lr2d23
    v_mov_b32 v234, 0
    v_mov_b32 v235, 0
    buffer_atomic_or_x2 v[234:235], v156, s[56:59], 0 offen offset:0 sc0 sc1
    s_waitcnt vmcnt(2)
    v_and_b32 v224, 1, v236
    v_mov_b32 v228, v236
    v_mov_b32 v229, v237
    v_cmpx_ne_u32 vcc, s76, v224
    s_cbranch_execz Lr2d23
    v_mov_b32 v236, 0
    v_mov_b32 v237, 0
    s_branch Lr222
Lr2d23:
    s_mov_b64 exec, -1
    v_mov_b32 v230, v228
    v_mov_b32 v231, v229
    s_nop 0
    v_permlane32_swap_b32 v228, v230
    v_permlane32_swap_b32 v229, v231
    v_pk_add_f32 v[228:229], v[228:229], v[230:231]
    s_or_b32 s72, 0, s71
    s_cmp_lg_u32 s72, 0
    v_add_f32_dpp v230, v228, v228 row_ror:8 row_mask:0xf bank_mask:0xf
    v_add_f32_dpp v231, v229, v229 row_ror:8 row_mask:0xf bank_mask:0xf
    v_add_f32_dpp v228, v228, v228 row_ror:8 row_mask:0xf bank_mask:0xf
    v_add_f32_dpp v229, v229, v229 row_ror:8 row_mask:0xf bank_mask:0xf
    s_nop 0
    v_permlane16_swap_b32 v228, v230
    v_permlane16_swap_b32 v229, v231
    v_pk_add_f32 v[152:153], v[152:153], v[228:229]
    v_pk_add_f32 v[152:153], v[152:153], v[230:231]
    v_cvt_pk_bf16_f32 v220, v152, v153
    s_nop 1
    v_mov_b32_dpp v221, v220 row_shl:1 row_mask:0xf bank_mask:0xf
    v_mov_b32_dpp v222, v220 row_shl:2 row_mask:0xf bank_mask:0xf
    v_mov_b32_dpp v223, v220 row_shl:3 row_mask:0xf bank_mask:0xf
    s_mov_b64 exec, 0x11
    s_cbranch_scc1 Lxa24
    buffer_store_dwordx4 v[220:223], v3, s[56:59], s75 offen
Lxd25:
    s_mov_b64 exec, -1
    s_add_u32 s77, s22, 21504
    s_add_u32 s21, s21, 1
    v_mov_b32 v218, s21
    v_mov_b32 v219, s21
    buffer_load_dwordx2 v[216:217], v11, s[56:59], s22 offen sc1
    s_mov_b64 exec, s[88:89]
    buffer_load_dwordx2 v[218:219], v11, s[56:59], s77 offen sc1
    s_mov_b64 exec, -1
    s_lshr_b32 s76, s21, 1
    s_lshl_b32 s74, s90, 5
    s_add_u32 s75, s74, s23
    s_add_u32 s75, s75, 10240
    v_pk_add_f32 v[152:153], v[152:153], v[154:155]
    s_mov_b32 s60, s26
    s_mov_b32 s61, s27
    s_mov_b32 s62, 1280
    s_mov_b32 s63, 0x20000
    s_and_b32 s78, s90, 0
    s_lshl_b32 s79, s78, 3
    s_lshl_b64 s[24:25], 0xff, s79
    s_xor_b32 s78, s78, s64
    s_cmp_eq_u32 s69, 2
    s_cselect_b64 s[24:25], s[24:25], -1
Lrd26:
    buffer_load_dwordx2 v[216:217], v11, s[56:59], s22 offen sc1
    s_mov_b64 exec, s[88:89]
    buffer_load_dwordx2 v[218:219], v11, s[56:59], s77 offen sc1
    s_mov_b64 exec, -1
    s_add_u32 s70, s70, 1
    s_cmp_ge_u32 s70, 4194304
    s_cbranch_scc1 Lok27
    s_waitcnt vmcnt(2)
    v_bitop3_b32 v224, v216, v217, s21 bitop3:0x7e
    v_bitop3_b32 v225, v218, v219, s21 bitop3:0x7e
    v_bitop3_b32 v224, v224, v225, 3 bitop3:0xa8
    v_cmp_ne_u32 vcc, 0, v224
    s_cbranch_vccnz Lrd26
Lok27:
    v_pk_add_f32 v[228:229], v[216:217], v[218:219]
    v_mov_b32 v237, 0
    v_mov_b32 v236, 0
    v_permlane32_swap_b32 v228, v229
    v_add_f32 v228, v228, v229
    v_mov_b32 v235, 0
    v_mov_b32 v234, 0
    v_add_f32_dpp v228, v228, v228 row_ror:8 row_mask:0xf bank_mask:0xf
    v_mov_b32 v229, v228
    v_mov_b32 v233, 0
    v_mov_b32 v232, 0
    v_permlane16_swap_b32 v228, v229
    v_add_f32 v228, v228, v229
    v_and_or_b32 v228, v228, -2, s76
    v_mov_b32 v229, v228
    s_cmp_eq_u32 s69, 2
    s_cselect_b32 s77, s78, 0
    v_permlane32_swap_b32 v228, v229
    s_and_b64 exec, s[4:5], s[24:25]
    s_cbranch_execz Lg_nopush
    buffer_store_dwordx2 v[228:229], v157, s[56:59], 0 offen offset:64 sc1
Lg_nopush:
    s_mov_b64 exec, s[4:5]
    s_cmp_lg_u32 s77, 0
    s_cbranch_scc1 Lg_exit
    buffer_atomic_or_x2 v[232:233], v156, s[56:59], 0 offen offset:64 sc0 sc1
    s_sleep 4
    buffer_atomic_or_x2 v[234:235], v156, s[56:59], 0 offen offset:64 sc0 sc1
    s_sleep 4
Lr228:
    buffer_atomic_or_x2 v[236:237], v156, s[56:59], 0 offen offset:64 sc0 sc1
    s_add_u32 s70, s70, 1
    s_cmp_ge_u32 s70, 4194304
    s_cbranch_scc1 Lr2d29
    s_waitcnt vmcnt(2)
    v_and_b32 v224, 1, v232
    v_mov_b32 v228, v232
    v_mov_b32 v229, v233
    v_cmpx_ne_u32 vcc, s76, v224
    s_cbranch_execz Lr2d29
    v_mov_b32 v232, 0
    v_mov_b32 v233, 0
    buffer_atomic_or_x2 v[232:233], v156, s[56:59], 0 offen offset:64 sc0 sc1
    s_waitcnt vmcnt(2)
    v_and_b32 v224, 1, v234
    v_mov_b32 v228, v234
    v_mov_b32 v229, v235
    v_cmpx_ne_u32 vcc, s76, v224
    s_cbranch_execz Lr2d29
    v_mov_b32 v234, 0
    v_mov_b32 v235, 0
    buffer_atomic_or_x2 v[234:235], v156, s[56:59], 0 offen offset:64 sc0 sc1
    s_waitcnt vmcnt(2)
    v_and_b32 v224, 1, v236
    v_mov_b32 v228, v236
    v_mov_b32 v229, v237
    v_cmpx_ne_u32 vcc, s76, v224
    s_cbranch_execz Lr2d29
    v_mov_b32 v236, 0
    v_mov_b32 v237, 0
    s_branch Lr228
Lr2d29:
    s_mov_b64 exec, -1
    v_mov_b32 v230, v228
    v_mov_b32 v231, v229
    s_lshr_b32 s72, s69, 1
    v_permlane32_swap_b32 v228, v230
    v_permlane32_swap_b32 v229, v231
    v_pk_add_f32 v[228:229], v[228:229], v[230:231]
    s_or_b32 s72, s72, s71
    s_cmp_lg_u32 s72, 0
    v_add_f32_dpp v230, v228, v228 row_ror:8 row_mask:0xf bank_mask:0xf
    v_add_f32_dpp v231, v229, v229 row_ror:8 row_mask:0xf bank_mask:0xf
    v_add_f32_dpp v228, v228, v228 row_ror:8 row_mask:0xf bank_mask:0xf
    v_add_f32_dpp v229, v229, v229 row_ror:8 row_mask:0xf bank_mask:0xf
    s_nop 0
    v_permlane16_swap_b32 v228, v230
    v_permlane16_swap_b32 v229, v231
    v_pk_add_f32 v[152:153], v[152:153], v[228:229]
    v_pk_add_f32 v[152:153], v[152:153], v[230:231]
    v_cvt_pk_bf16_f32 v220, v152, v153
    s_nop 1
    v_mov_b32_dpp v221, v220 row_shl:1 row_mask:0xf bank_mask:0xf
    v_mov_b32_dpp v222, v220 row_shl:2 row_mask:0xf bank_mask:0xf
    v_mov_b32_dpp v223, v220 row_shl:3 row_mask:0xf bank_mask:0xf
    s_mov_b64 exec, 0x11
    s_cbranch_scc1 Lg_out
    buffer_store_dwordx4 v[220:223], v3, s[56:59], s75 offen
Lxd31:
    s_mov_b64 exec, -1
    s_branch Lg_next
Lg_out:
    s_cmp_eq_u32 s69, 2
    s_cbranch_scc0 Lg_xslow
    buffer_store_dwordx4 v[220:223], v3, s[60:63], s74 offen
    s_cmp_lg_u32 s90, 0
    s_cbranch_scc1 Lg_exit
    s_mov_b64 exec, 1
    v_mov_b32 v216, s91
    buffer_store_dword v216, v3, s[56:59], 0 offen sc1
Lg_exit:
    s_endpgm
Lg_bulk2:
    ds_write_b32 v9, v209 offset:27392
    v_lshlrev_b32 v200, 7, v0
    v_lshlrev_b32 v201, 4, v0
    ds_read_b32 v236, v8 offset:27412
    v_mov_b32 v224, -1
    v_mov_b32 v225, -1
    v_mov_b32 v226, -1
    v_mov_b32 v227, -1
    s_lshl_b32 s90, s67, 4
    s_add_u32 s90, s90, s65
    s_sub_u32 s90, s90, 16
    s_cmp_lt_u32 s65, 16
    s_cselect_b32 s90, 100, s90
    s_mul_i32 s3, s82, 2688
    s_mul_i32 s73, s67, 640
    s_add_u32 s3, s3, s73
    s_add_u32 s3, s3, 2097152
    s_mov_b32 s40, s12
    s_mov_b32 s41, s13
    s_mov_b32 s42, 4194304
    s_mov_b32 s43, 0x20000
    s_mov_b32 s44, s14
    s_mov_b32 s45, s15
    s_mov_b32 s46, 5242880
    s_mov_b32 s47, 0x20000
    s_mov_b32 s48, s18
    s_mov_b32 s49, s19
    s_mov_b32 s50, 2211840
    s_mov_b32 s51, 0x20000
    s_mov_b32 s52, s22
    s_mov_b32 s53, s23
    s_mov_b32 s54, 2211840
    s_mov_b32 s55, 0x20000
    v_lshl_add_u32 v199, v188, 4, v2
    v_lshl_add_u32 v199, v199, 13, v189
    s_lshr_b32 s79, s77, 1
    s_lshl_b32 s79, s79, 7
    s_and_b32 s72, s67, 1
    s_lshl_b32 s72, s72, 3
    s_add_u32 s79, s79, s72
    s_lshl_b32 s79, s79, 13
    s_add_u32 s79, s79, s83
    v_add_u32 v199, s79, v199
    s_lshl_b32 s73, s67, 11
    s_add_u32 s73, s73, 147456
    v_xor_b32 v193, v201, v190
    v_add_u32 v193, s73, v193
    v_add_u32 v194, s73, v194
    v_xor_b32 v195, 32, v194
    s_lshl_b32 s73, s67, 7
    s_add_u32 s73, s73, 158592
    v_lshl_add_u32 v204, v2, 4, s73
    v_lshrrev_b32 v197, 1, v2
    v_lshlrev_b32 v12, 2, v197
    v_lshl_add_u32 v12, v1, 5, v12
    v_lshl_add_u32 v12, s67, 3, v12
    v_add_u32 v12, 131072, v12
    v_and_b32 v198, 3, v0
    v_lshl_add_u32 v197, v2, 2, v198
    v_lshlrev_b32 v14, 1, v197
    v_lshlrev_b32 v13, 5, v197
    v_add_u32 v13, 131072, v13
    s_and_b32 s74, s64, 3
    s_lshr_b32 s72, s64, 2
    s_lshl_b32 s72, s72, 13
    v_lshl_add_u32 v208, s74, 15, v200
    v_add_u32 v208, s72, v208
    s_lshr_b32 s73, s65, 4
    v_lshl_add_u32 v208, s73, 14, v208
    s_bfe_u32 s73, s65, 0x10003
    v_lshl_add_u32 v208, s73, 12, v208
    v_add_u32 v208, 131072, v208
    v_bfe_u32 v198, v0, 3, 1
    v_lshlrev_b32 v10, 14, v2
    v_lshl_add_u32 v10, v198, 12, v10
    v_and_b32 v197, 7, v0
    v_xor_b32 v198, v197, v2
    v_lshl_add_u32 v10, v198, 4, v10
    v_lshl_add_u32 v10, s74, 18, v10
    v_add_u32 v10, s72, v10
    s_lshr_b32 s73, s65, 3
    v_lshl_add_u32 v10, s73, 10, v10
    v_lshl_add_u32 v10, s77, 7, v10
    v_add_u32 v10, 524288, v10
    s_mul_i32 s74, s74, 81920
    s_add_u32 s74, s74, s72
    s_lshr_b32 s72, s90, 3
    s_lshl_b32 s72, s72, 14
    s_and_b32 s73, s90, 7
    s_lshl_b32 s73, s73, 10
    s_add_u32 s72, s72, s73
    s_add_u32 s72, s72, 5767168
    s_add_u32 s74, s74, s72
    v_lshrrev_b32 v198, 3, v0
    v_lshlrev_b32 v156, 7, v198
    v_lshl_add_u32 v156, v197, 3, v156
    v_add_u32 v156, s74, v156
    v_and_b32 v157, 3, v198
    v_mul_u32_u24 v157, 81920, v157
    v_lshrrev_b32 v198, 5, v0
    v_lshl_add_u32 v157, v198, 13, v157
    v_lshl_add_u32 v157, v197, 3, v157
    v_lshl_add_u32 v157, s64, 7, v157
    v_add_u32 v157, s72, v157
    v_lshrrev_b32 v206, 1, v1
    v_xor_b32 v206, v206, v2
    v_lshlrev_b32 v206, 4, v206
    v_lshl_add_u32 v206, v1, 7, v206
    v_add_u32 v206, s95, v206
    v_xor_b32 v207, 64, v206
    v_lshrrev_b32 v198, 3, v0
    v_mul_u32_u24 v11, 2688, v198
    v_lshl_add_u32 v11, v197, 3, v11
    v_lshlrev_b32 v196, 2, v197
    s_lshr_b32 s74, s65, 2
    s_lshl_b32 s74, s74, 3
    s_add_u32 s74, s74, s64
    s_cmp_lt_u32 s74, 27
    s_cselect_b32 s81, 1, 0
    s_lshl_b32 s80, s74, 6
    s_and_b32 s74, s65, 3
    s_lshl_b32 s74, s74, 4
    s_add_u32 s80, s80, s74
    s_mov_b32 s88, -1
    s_cmp_lt_u32 s64, 3
    s_cselect_b32 s89, -1, 0
    v_bfe_u32 v147, v0, 3, 2
    v_mul_u32_u24 v147, 40, v147
    v_bfe_u32 v198, v0, 1, 2
    v_lshrrev_b32 v197, 5, v0
    v_lshl_add_u32 v198, v197, 2, v198
    v_add_u32 v147, v147, v198
    v_mul_u32_u24 v147, 3456, v147
    v_and_b32 v198, 16, v189
    v_add_u32 v147, v147, v198
    s_mul_i32 s0, s67, 552960
    s_lshl_b32 s79, s80, 1
    s_add_u32 s0, s0, s79
    v_lshrrev_b32 v167, 2, v0
    v_mul_u32_u24 v167, 1280, v167
    v_add_u32 v167, v167, v189
    s_mul_i32 s1, s80, 1280
    s_add_u32 s1, s1, s75
    s_and_b32 s72, s65, 3
    s_lshl_b32 s72, s72, 2
    s_add_u32 s72, s72, s67
    s_mul_i32 s72, s72, 138240
    s_add_u32 s72, s72, s79
    v_mul_u32_u24 v146, 3456, v0
    v_add_u32 v146, s72, v146
    s_mul_i32 s72, s80, 1280
    s_mul_i32 s73, s67, 5120
    s_add_u32 s72, s72, s73
    v_add_u32 v166, s72, v200
    s_mul_i32 s76, s82, 20480
    s_add_u32 s76, s76, s73
    v_lshl_add_u32 v191, v2, 3, v188
    v_mul_u32_u24 v191, 1280, v191
    v_add_u32 v191, v191, v189
    s_lshl_b32 s22, s90, 6
    s_mul_i32 s73, s64, 86016
    s_add_u32 s22, s22, s73
    s_add_u32 s22, s22, 2097152
    s_waitcnt vmcnt(0) lgkmcnt(0)
    ds_write_b32 v9, v209 offset:27328
    v_readfirstlane_b32 s91, v236
    s_nop 0
    s_mul_i32 s78, s91, 0x9e3779b1
    s_mul_i32 s72, s83, 640
    s_add_u32 s72, s72, s75
    s_add_u32 s73, s72, 5120
    s_lshl_b32 s74, s67, 13
    s_add_u32 s74, s74, 32768
    s_lshl_b32 s77, s90, 5
Llw32:
    ds_read_b128 v[216:219], v8 offset:27376
    s_add_u32 s70, s70, 1
    s_cmp_ge_u32 s70, 4194304
    s_cbranch_scc1 Lok33
    s_waitcnt lgkmcnt(0)
    v_min3_u32 v216, v216, v217, v218
    v_min_u32 v216, v216, v219
    v_cmp_gt_u32 vcc, s69, v216
    s_cbranch_vccnz Llw32
Lok33:
    s_mov_b32 exec_hi, 0xff
    s_mov_b32 exec_lo, 0x0
    buffer_load_dword v228, v200, s[44:47], s76 offen
    s_mov_b32 exec_lo, -1
    s_mov_b32 exec_hi, -1
    buffer_load_dwordx4 v[220:223], v200, s[56:59], s74 offen sc1
    s_mov_b32 s76, 0
    buffer_load_dwordx4 v[72:75], v199, s[40:43], s76 offen
    s_mov_b32 s76, 524288
    buffer_load_dwordx4 v[76:79], v199, s[40:43], s76 offen
    s_mov_b32 s76, 32768
    buffer_load_dwordx4 v[80:83], v199, s[40:43], s76 offen
    s_mov_b32 s76, 557056
    buffer_load_dwordx4 v[84:87], v199, s[40:43], s76 offen
    s_waitcnt vmcnt(5)
    buffer_load_dwordx4 v[88:91], v191, s[44:47], s72 offen offset:0
    buffer_load_dwordx4 v[92:95], v191, s[44:47], s73 offen offset:0
    buffer_load_dwordx4 v[96:99], v191, s[44:47], s72 offen offset:64
    buffer_load_dwordx4 v[100:103], v191, s[44:47], s73 offen offset:64
    buffer_load_dwordx4 v[104:107], v191, s[44:47], s72 offen offset:128
    buffer_load_dwordx4 v[108:111], v191, s[44:47], s73 offen offset:128
    buffer_load_dwordx4 v[112:115], v191, s[44:47], s72 offen offset:192
    buffer_load_dwordx4 v[116:119], v191, s[44:47], s73 offen offset:192
    buffer_load_dwordx4 v[120:123], v191, s[44:47], s72 offen offset:256
    buffer_load_dwordx4 v[124:127], v191, s[44:47], s73 offen offset:256
    s_mov_b32 s60, s4
    s_mov_b32 s61, s5
    s_mov_b32 s62, 1280
    s_mov_b32 s63, 0x20000
    buffer_load_dword v152, v196, s[60:63], s77 offen
    s_mov_b32 s60, s24
    s_mov_b32 s61, s25
    s_mov_b32 s62, 1280
    s_mov_b32 s63, 0x20000
    buffer_load_dword v154, v196, s[60:63], s77 offen
    s_mov_b32 s60, s20
    s_mov_b32 s61, s21
    s_mov_b32 s62, 3456
    s_mov_b32 s63, 0x20000
    buffer_load_short_d16_hi v14, v14, s[60:63], s79 offen
    s_bfe_u32 s76, s65, 0x20002
    s_lshl_b32 s76, s76, 18
    s_lshl_b32 s23, s64, 15
    s_add_u32 s76, s76, s23
    s_bfe_u32 s23, s65, 0x10001
    s_lshl_b32 s23, s23, 14
    s_add_u32 s76, s76, s23
    s_lshr_b32 s23, s65, 4
    s_lshl_b32 s23, s23, 13
    s_add_u32 s76, s76, s23
    s_and_b32 s23, s65, 1
    s_lshl_b32 s23, s23, 12
    s_add_u32 s76, s76, s23
    s_add_u32 s76, s76, 4718592
    s_lshl_b32 s23, s67, 10
    s_add_u32 s76, s76, s23
    buffer_store_dwordx4 v[224:227], v201, s[56:59], s76 offen sc1
    s_lshl_b32 s36, s67, 7
    s_add_u32 s36, s36, 158592
    s_add_u32 s33, s68, 64512
    s_add_u32 s34, s68, 129024
    s_add_u32 s35, s68, 193536
    s_lshl_b32 s21, s69, 1
    s_sub_u32 s21, s21, 2
    s_mul_i32 s23, s64, 1280
    s_add_u32 s23, s23, s68
    s_add_u32 s23, s23, 81920
    v_mul_u32_u24 v228, 2688, v0
    v_mul_u32_u24 v229, 10240, v0
    s_min_u32 s37, s90, 39
    s_lshl_b32 s37, s37, 5
    s_add_u32 s37, s37, s23
    s_cmp_lt_u32 s90, 40
    s_cselect_b32 exec_lo, -1, 1
    s_mov_b32 exec_hi, 0
    buffer_load_dword v230, v228, s[56:59], s22 offen sc1
    s_mov_b64 exec, 3
    buffer_load_dword v230, v229, s[56:59], s37 offen sc1
    s_mov_b64 exec, -1
    ds_write_b32 v9, v209 offset:27424
    s_waitcnt vmcnt(18)
    ds_write_b128 v193, v[72:75]
    ds_write_b128 v193, v[76:79] offset:1024
    ds_read_b64_tr_b16 v[72:73], v194 offset:0
    ds_read_b64_tr_b16 v[74:75], v194 offset:1024
    ds_read_b64_tr_b16 v[76:77], v195 offset:0
    ds_read_b64_tr_b16 v[78:79], v195 offset:1024
    s_waitcnt vmcnt(16)
    ds_write_b128 v193, v[80:83]
    ds_write_b128 v193, v[84:87] offset:1024
    ds_read_b64_tr_b16 v[80:81], v194 offset:0
    ds_read_b64_tr_b16 v[82:83], v194 offset:1024
    ds_read_b64_tr_b16 v[84:85], v195 offset:0
    ds_read_b64_tr_b16 v[86:87], v195 offset:1024
    s_waitcnt vmcnt(14)
    ds_write_b128 v193, v[88:91]
    ds_write_b128 v193, v[92:95] offset:1024
    ds_read_b64_tr_b16 v[88:89], v194 offset:0
    ds_read_b64_tr_b16 v[90:91], v194 offset:1024
    ds_read_b64_tr_b16 v[92:93], v195 offset:0
    ds_read_b64_tr_b16 v[94:95], v195 offset:1024
    s_waitcnt vmcnt(12)
    ds_write_b128 v193, v[96:99]
    ds_write_b128 v193, v[100:103] offset:1024
    ds_read_b64_tr_b16 v[96:97], v194 offset:0
    ds_read_b64_tr_b16 v[98:99], v194 offset:1024
    ds_read_b64_tr_b16 v[100:101], v195 offset:0
    ds_read_b64_tr_b16 v[102:103], v195 offset:1024
    s_waitcnt vmcnt(10)
    ds_write_b128 v193, v[104:107]
    ds_write_b128 v193, v[108:111] offset:1024
    ds_read_b64_tr_b16 v[104:105], v194 offset:0
    ds_read_b64_tr_b16 v[106:107], v194 offset:1024
    ds_read_b64_tr_b16 v[108:109], v195 offset:0
    ds_read_b64_tr_b16 v[110:111], v195 offset:1024
    s_waitcnt vmcnt(8)
    ds_write_b128 v193, v[112:115]
    ds_write_b128 v193, v[116:119] offset:1024
    ds_read_b64_tr_b16 v[112:113], v194 offset:0
    ds_read_b64_tr_b16 v[114:115], v194 offset:1024
    ds_read_b64_tr_b16 v[116:117], v195 offset:0
    ds_read_b64_tr_b16 v[118:119], v195 offset:1024
    s_getreg_b32 s76, hwreg(HW_REG_XCC_ID)
    s_and_b32 s76, s76, 15
Lg_fb:
    v_xor_b32 v220, s78, v220
    v_xor_b32 v221, s78, v221
    v_xor_b32 v222, s78, v222
    v_xor_b32 v223, s78, v223
    v_max3_u32 v221, v220, v221, v222
    v_max_u32 v221, v221, v223
    v_cmp_lt_u32 vcc, 15, v221
    s_cbranch_vccnz Lg_fbre
Lg_fbok:
    v_cmp_ne_u32 vcc, s76, v220
    s_bitcmp1_b32 s64, 0
    s_cselect_b32 s72, vcc_hi, vcc_lo
    s_lshr_b32 s73, s64, 1
    s_cmp_eq_u32 s73, s67
    s_cselect_b32 s72, s72, 0
    s_cmp_lg_u32 s72, 0
    s_cselect_b32 s72, 2, 1
    v_mov_b32 v220, s72
    ds_write_b32 v9, v220 offset:27440
    ds_read_b32 v212, v8 offset:27472
    s_and_b32 s73, s64, 3
    v_bfe_u32 v213, v0, 3, 2
    s_waitcnt lgkmcnt(0)
    v_lshrrev_b32 v213, v213, v212
    v_lshrrev_b32 v212, s73, v212
    v_and_b32 v212, 0x2000, v212
    v_and_b32 v213, 0x2000, v213
    v_xor_b32 v208, v212, v208
    v_xor_b32 v10, v212, v10
    v_xor_b32 v156, v212, v156
    v_xor_b32 v157, v213, v157
    v_and_b32 v212, 0x2000, v10
    v_or_b32 v210, v210, v212
    v_xor_b32 v205, 64, v10
    s_waitcnt lgkmcnt(0)
    s_mov_b32 s20, 1
    s_mov_b32 s38, 0x000f000f
    s_mov_b32 s39, 0x000f000f
    s_barrier
    s_branch Lg_b2x
Lg_rest:
    s_mov_b32 s20, 0
    s_waitcnt vmcnt(5)
    ds_write_b128 v193, v[120:123]
    ds_write_b128 v193, v[124:127] offset:1024
    ds_read_b64_tr_b16 v[120:121], v194 offset:0
    ds_read_b64_tr_b16 v[122:123], v194 offset:1024
    ds_read_b64_tr_b16 v[124:125], v195 offset:0
    ds_read_b64_tr_b16 v[126:127], v195 offset:1024
    v_mov_b32 v188, 0
    v_mov_b32 v189, 0
    v_mov_b32 v190, 0
    v_mov_b32 v191, 0
    v_mov_b32 v192, 0
    v_mov_b32 v193, 0
    v_mov_b32 v194, 0
    v_mov_b32 v195, 0
    v_mov_b32 v196, 0
    v_mov_b32 v197, 0
    v_mov_b32 v198, 0
    v_mov_b32 v199, 0
    v_mov_b32 v200, 0
    v_mov_b32 v201, 0
    v_mov_b32 v202, 0
    v_mov_b32 v203, 0
    v_and_b32 v14, 0xffff0000, v14
    v_and_b32 v153, 0xffff0000, v152
    v_lshlrev_b32 v152, 16, v152
    v_and_b32 v155, 0xffff0000, v154
    v_lshlrev_b32 v154, 16, v154
    s_lshl_b32 s72, s64, 3
    s_lshl_b64 s[24:25], 0xff, s72
    s_not_b64 s[4:5], s[24:25]
    s_and_b32 s24, s4, 0x55555555
    s_and_b32 s25, s5, 0x55555555
    ds_read_b128 v[240:243], v8 offset:27440
    s_waitcnt lgkmcnt(0)
    v_max3_u32 v240, v240, v241, v242
    v_max_u32 v240, v240, v243
    s_nop 0
    v_readfirstlane_b32 s71, v240
    s_nop 0
    s_sub_u32 s71, s71, 1
    s_branch Lg_rest_back
Lg_ffnre:
    s_waitcnt vmcnt(0)
    buffer_load_dwordx4 v[128:131], v147, s[48:51], s0 offen
    s_add_u32 s0, s0, 27648
    buffer_load_dwordx4 v[132:135], v147, s[48:51], s0 offen
    s_add_u32 s0, s0, 27648
    buffer_load_dwordx4 v[136:139], v147, s[48:51], s0 offen
    s_add_u32 s0, s0, 27648
    buffer_load_dwordx4 v[140:143], v147, s[48:51], s0 offen
    s_add_u32 s0, s0, 27648
    buffer_load_dwordx4 v[144:147], v147, s[48:51], s0 offen
    buffer_load_dwordx4 v[148:151], v167, s[52:55], s1 offen offset:0
    buffer_load_dwordx4 v[152:155], v167, s[52:55], s1 offen offset:64
    buffer_load_dwordx4 v[156:159], v167, s[52:55], s1 offen offset:128
    buffer_load_dwordx4 v[160:163], v167, s[52:55], s1 offen offset:192
    buffer_load_dwordx4 v[164:167], v167, s[52:55], s1 offen offset:256
    s_lshl_b32 s78, s67, 11
    s_add_u32 s78, s78, 147456
    v_lshl_add_u32 v216, v0, 4, s78
    v_lshl_add_u32 v217, v0, 3, s78
    v_lshrrev_b32 v218, 2, v0
    v_and_b32 v219, 3, v0
    v_lshlrev_b32 v219, 3, v219
    v_lshl_add_u32 v218, v218, 6, v219
    v_add_u32 v218, s78, v218
    s_waitcnt vmcnt(9)
    ds_write_b128 v216, v[128:131]
    ds_read_b64_tr_b16 v[128:129], v217 offset:0
    ds_read_b64_tr_b16 v[130:131], v217 offset:512
    s_waitcnt vmcnt(8)
    ds_write_b128 v216, v[132:135]
    ds_read_b64_tr_b16 v[132:133], v217 offset:0
    ds_read_b64_tr_b16 v[134:135], v217 offset:512
    s_waitcnt vmcnt(7)
    ds_write_b128 v216, v[136:139]
    ds_read_b64_tr_b16 v[136:137], v217 offset:0
    ds_read_b64_tr_b16 v[138:139], v217 offset:512
    s_waitcnt vmcnt(6)
    ds_write_b128 v216, v[140:143]
    ds_read_b64_tr_b16 v[140:141], v217 offset:0
    ds_read_b64_tr_b16 v[142:143], v217 offset:512
    s_waitcnt vmcnt(5)
    ds_write_b128 v216, v[144:147]
    ds_read_b64_tr_b16 v[144:145], v217 offset:0
    ds_read_b64_tr_b16 v[146:147], v217 offset:512
    s_waitcnt vmcnt(4)
    ds_write_b128 v216, v[148:151]
    ds_read_b64_tr_b16 v[148:149], v218 offset:0
    ds_read_b64_tr_b16 v[150:151], v218 offset:32
    s_waitcnt vmcnt(3)
    ds_write_b128 v216, v[152:155]
    ds_read_b64_tr_b16 v[152:153], v218 offset:0
    ds_read_b64_tr_b16 v[154:155], v218 offset:32
    s_waitcnt vmcnt(2)
    ds_write_b128 v216, v[156:159]
    ds_read_b64_tr_b16 v[156:157], v218 offset:0
    ds_read_b64_tr_b16 v[158:159], v218 offset:32
    s_waitcnt vmcnt(1)
    ds_write_b128 v216, v[160:163]
    ds_read_b64_tr_b16 v[160:161], v218 offset:0
    ds_read_b64_tr_b16 v[162:163], v218 offset:32
    s_waitcnt vmcnt(0)
    ds_write_b128 v216, v[164:167]
    ds_read_b64_tr_b16 v[164:165], v218 offset:0
    ds_read_b64_tr_b16 v[166:167], v218 offset:32
    s_waitcnt lgkmcnt(0)
    s_branch Lg_ffnre_back
Lg_fcwait:
Ll11:
    ds_read_b32 v228, v8 offset:27408
    s_add_u32 s70, s70, 1
    s_cmp_ge_u32 s70, 4194304
    s_cbranch_scc1 Lok2
    s_waitcnt lgkmcnt(0)
    v_cmp_eq_u32 vcc, 0, v228
    s_cbranch_vccnz Ll11
Lok2:
    s_branch Lg_s1
Lms10:
    s_nop 7
    v_pk_add_f32 v[240:241], v[240:241], v[242:243]
    v_add_f32 v240, v240, v241
    v_mul_f32 v240, v240, v232
    v_and_or_b32 v240, v240, -4, s21
    buffer_store_dword v240, v3, s[56:59], s3 offen offset:0 sc1
    v_pk_add_f32 v[244:245], v[244:245], v[246:247]
    v_add_f32 v244, v244, v245
    v_mul_f32 v244, v244, v232
    v_and_or_b32 v244, v244, -4, s21
    buffer_store_dword v244, v3, s[56:59], s3 offen offset:256 sc1
    v_pk_add_f32 v[248:249], v[248:249], v[250:251]
    v_add_f32 v248, v248, v249
    v_mul_f32 v248, v248, v232
    v_and_or_b32 v248, v248, -4, s21
    s_mov_b32 exec_hi, 0
    buffer_store_dword v248, v3, s[56:59], s3 offen offset:512 sc1
    s_mov_b32 exec_hi, -1
    s_branch Lmd11
Lms16:
    s_nop 7
    v_and_or_b32 v248, v248, -4, s21
    s_mov_b32 exec_hi, 0
    buffer_store_dword v248, v3, s[56:59], s3 offen offset:512 sc1
    s_mov_b32 exec_hi, -1
    v_and_or_b32 v240, v240, -4, s21
    buffer_store_dword v240, v3, s[56:59], s3 offen offset:0 sc1
    v_and_or_b32 v244, v244, -4, s21
    buffer_store_dword v244, v3, s[56:59], s3 offen offset:256 sc1
    s_branch Lmd17
Lxa24:
    buffer_store_dwordx4 v[220:223], v3, s[56:59], s75 offen sc1
    s_branch Lxd25
Lg_xslow:
    buffer_store_dwordx4 v[220:223], v3, s[56:59], s75 offen sc1
    s_branch Lxd31
Lg_fbre:
    s_add_u32 s70, s70, 1
    s_cmp_ge_u32 s70, 4194304
    s_cbranch_scc1 Lg_fbok
    buffer_load_dwordx4 v[220:223], v200, s[56:59], s74 offen sc1
    s_waitcnt vmcnt(0)
    s_branch Lg_fb
La_dec:
    v_mov_b32 v220, 131072
Llw34:
    ds_read_b128 v[216:219], v220 offset:27488
    s_add_u32 s70, s70, 1
    s_cmp_ge_u32 s70, 4194304
    s_cbranch_scc1 Lok35
    s_waitcnt lgkmcnt(0)
    v_min3_u32 v216, v216, v217, v218
    v_min_u32 v216, v216, v219
    v_cmp_gt_u32 vcc, s69, v216
    s_cbranch_vccnz Llw34
Lok35:
    ds_read_b64 v[216:217], v220 offset:27480
    s_waitcnt lgkmcnt(0)
    v_cmp_gt_u32 vcc, v217, v216
    s_nop 0
    s_and_b32 s3, vcc_lo, 1
    s_branch La_dec_back
La_pub:
    s_xor_b32 s3, s3, s87
    v_mov_b32 v220, s3
    v_mov_b32 v221, s3
    v_mov_b32 v222, s3
    v_mov_b32 v223, s3
    s_lshl_b32 s3, s64, 7
    s_add_u32 s3, s3, 4096
    s_mov_b64 exec, 0xff
    buffer_store_dwordx4 v[220:223], v226, s[56:59], s3 offen sc1
    s_mov_b64 exec, -1
    s_waitcnt vmcnt(1)
    s_branch La_pub_back2
La_flre:
    s_add_u32 s70, s70, 1
    s_cmp_ge_u32 s70, 4194304
    s_cbranch_scc1 La_flok
    buffer_load_dwordx4 v[252:255], v249, s[56:59], 0 offen sc1
    s_waitcnt vmcnt(0)
    s_branch La_fl
La_fhr:
    s_add_u32 s70, s70, 1
    s_cmp_ge_u32 s70, 4194304
    s_cbranch_scc1 La_fhk
    ds_read_b32 v239, v236 offset:27344
    ds_read_b128 v[240:243], v232
    ds_read_b128 v[244:247], v233
    ds_read_b128 v[248:251], v234
    ds_read_b128 v[252:255], v235
    s_branch La_fh
La_ft:
    v_mov_b32 v232, 131072
Llw47:
    ds_read_b128 v[228:231], v232 offset:27424
    s_add_u32 s70, s70, 1
    s_cmp_ge_u32 s70, 4194304
    s_cbranch_scc1 Lok48
    s_waitcnt lgkmcnt(0)
    v_min3_u32 v228, v228, v229, v230
    v_min_u32 v228, v228, v231
    v_cmp_gt_u32 vcc, s69, v228
    s_cbranch_vccnz Llw47
Lok48:
    s_and_b32 s72, s65, 24
    s_add_u32 s72, s72, s64
    s_cmp_ge_u32 s72, 27
    s_cbranch_scc1 La_noffn
    s_and_b32 s73, s65, 7
    s_lshl_b32 s73, s73, 2
    s_add_u32 s73, s73, s67
    s_mul_i32 s73, s73, 20
    v_mbcnt_lo_u32_b32 v224, -1, s73
    v_mul_u32_u24 v225, 3456, v224
    v_lshlrev_b32 v226, 7, v224
    s_lshl_b32 s73, s72, 7
    s_mul_i32 s72, s72, 81920
    s_mov_b64 exec, 0xfffff
    buffer_load_dword v227, v225, s[48:51], s73 offen
    buffer_load_dword v227, v226, s[52:55], s72 offen
    s_mov_b64 exec, -1
    s_waitcnt vmcnt(2)
    s_branch La_ft_back
La_noffn:
    s_waitcnt vmcnt(0)
    s_branch La_ft_back
Lcode_end:
.section .rodata,"a"
.p2align 6
.amdhsa_kernel interleave_layers__compressed_kv_cla__dense_activation_gelu__decode_kernel
  .amdhsa_next_free_vgpr 256
  .amdhsa_next_free_sgpr 102
  .amdhsa_accum_offset 256
  .amdhsa_group_segment_fixed_size 0
  .amdhsa_kernarg_size 112
  .amdhsa_user_sgpr_count 2
  .amdhsa_user_sgpr_kernarg_segment_ptr 1
  .amdhsa_system_sgpr_workgroup_id_x 1
.end_amdhsa_kernel
```
